```python
import torch

def _softmax(x, axis=-1):
    return torch.softmax(x, dim=axis)
def _gelu(x):
    return torch.nn.functional.gelu(x, approximate="tanh")
def _silu(x):
    return torch.nn.functional.silu(x)
def _sigmoid(x):
    return torch.sigmoid(x)
def _layernorm(x, axis=-1, eps=1e-5):
    m = x.mean(dim=axis, keepdim=True)
    v = x.var(dim=axis, keepdim=True, unbiased=False)
    return (x - m) / torch.sqrt(v + eps)
def _scatter_add(tgt, idx, src, axis=0):
    return tgt.clone().index_add_(axis, idx, src)
def _segment_sum(src, seg, n):
    out = torch.zeros((n,) + src.shape[1:], dtype=src.dtype)
    return out.index_add_(0, seg, src)
def _pad(x, pw):
    flat = tuple(v for pair in reversed(pw) for v in pair)
    return torch.nn.functional.pad(x, flat)

kernel_name = 'standalone__mha_block__prompt'

def setup_inputs():

    _w = (lambda a: (lambda t: t.to(torch.bfloat16) if t.is_floating_point() else t)(torch.as_tensor(a)))
    B, S, D, H = 1, 2048, 448, 16
    return {
        "x": _w((lambda *s: torch.randn(*s, dtype=torch.bfloat16) * 0.2)(B, S, D)),
        "wqkv": _w((lambda *s: torch.randn(*s, dtype=torch.bfloat16) * 0.2)(D, 3 * D)),
        "wo": _w((lambda *s: torch.randn(*s, dtype=torch.bfloat16) * 0.05)(D, D)),
    }

def reference(x, wqkv, wo):
    B, S, D = x.shape
    H = 16
    Dh = D // H
    qkv = (lambda x, *d: x.permute(*d))((x @ wqkv).reshape(B, S, 3, H, Dh), 2, 0, 3, 1, 4)
    q, k, v = qkv[0], qkv[1], qkv[2]
    scores = torch.einsum("bhqd,bhkd->bhqk", q, k) * (Dh ** -0.5)
    p = _softmax(scores, axis=-1)
    o = torch.einsum("bhqk,bhkd->bhqd", p, v)
    return (lambda x, *d: x.permute(*d))(o, 0, 2, 1, 3).reshape(B, S, D) @ wo
```

```asm
; @launch grid=(256,1,1) block=(512,1,1) lds=163840
.amdgcn_target "amdgcn-amd-amdhsa--gfx950"
.text
.globl standalone__mha_block__prompt_kernel
.p2align 8
.type standalone__mha_block__prompt_kernel,@function
standalone__mha_block__prompt_kernel:

    s_cmp_ge_u32 s2, 256
    s_cbranch_scc1 L_end
    s_load_dwordx8 s[44:51], s[0:1], 0
    s_load_dwordx4 s[52:55], s[0:1], 32
    v_and_b32 v1, 63, v0
    v_lshrrev_b32 v2, 6, v0
    s_and_b32 s42, s2, 7
    s_lshr_b32 s43, s2, 3
    v_readfirstlane_b32 s28, v2
    s_lshl_b32 s31, s42, 1
    s_and_b32 s56, s43, 1
    s_add_u32 s31, s31, s56
    s_lshr_b32 s32, s43, 1
    s_and_b32 s56, s43, 3
    s_lshl_b32 s56, s56, 2
    s_lshl_b32 s57, s42, 3
    s_lshr_b32 s58, s43, 2
    s_add_u32 s57, s57, s58
    s_and_b32 s58, s42, 1
    s_mul_i32 s58, s58, 28
    s_add_u32 s58, s58, s43
    s_lshr_b32 s59, s58, 3
    s_lshl_b32 s59, s59, 2
    s_add_u32 s59, s59, 14
    s_and_b32 s58, s58, 7
    s_bfe_u32 s60, s42, 0x10001
    s_lshl_b32 s60, s60, 3
    s_add_u32 s58, s58, s60
    s_cmp_ge_u32 s43, 28
    s_cselect_b32 s60, 2, 1
    s_cmp_ge_u32 s42, 4
    s_cselect_b32 s34, s59, s56
    s_cselect_b32 s35, s58, s57
    s_cselect_b32 s33, s60, 0
    s_lshr_b32 s29, s28, 2
    s_and_b32 s30, s28, 3
    s_cmp_eq_u32 s29, 0
    s_cbranch_scc1 L_A_cons

    s_lshr_b32 s67, s34, 2
    s_add_u32 s67, s67, s35
    s_mul_i32 s57, s67, 147
    s_lshr_b32 s57, s57, 10
    s_mul_i32 s57, s57, 7
    s_sub_u32 s67, s67, s57
    s_mul_i32 s70, s35, 57344
    s_mul_i32 s57, s30, 14336
    s_add_u32 s70, s70, s57
    s_lshl_b32 s71, s34, 6
    s_mul_i32 s57, s30, 43008
    s_add_u32 s71, s71, s57
    s_lshl_b32 s64, s30, 11
    s_lshl_b32 s65, s30, 12
    s_add_u32 s65, s65, 8192
    v_lshrrev_b32 v5, 3, v1
    v_and_b32 v6, 7, v1
    v_lshrrev_b32 v7, 1, v5
    v_xor_b32 v6, v6, v7
    v_mul_u32_u24 v5, 896, v5
    v_lshl_add_u32 v16, v6, 4, v5
    v_xor_b32 v17, 64, v16
    v_lshrrev_b32 v5, 4, v1
    v_and_b32 v6, 15, v1
    v_lshlrev_b32 v7, 2, v5
    v_xor_b32 v6, v6, v7
    v_mul_u32_u24 v5, 2688, v5
    v_lshl_add_u32 v18, v6, 4, v5
    s_waitcnt lgkmcnt(0)

    s_mov_b32 s4, s44
    s_mov_b32 s5, s45
    s_mov_b32 s6, 1835008
    s_mov_b32 s7, 0x00020000

    s_mov_b32 s8, s46
    s_mov_b32 s9, s47
    s_mov_b32 s10, 1204224
    s_mov_b32 s11, 0x00020000

    s_cmp_eq_u32 s33, 2
    s_cbranch_scc1 L_A_l0
    s_lshl_b32 s43, s67, 7
    s_add_u32 m0, s64, 0
    s_add_u32 s43, s43, s70
    buffer_load_dwordx4 v16, s[4:7], s43 offen lds
    s_add_u32 m0, s64, 1024
    s_add_u32 s43, s43, 7168
    buffer_load_dwordx4 v17, s[4:7], s43 offen lds

    s_mul_i32 s3, s67, 172032
    s_add_u32 m0, s65, 0
    s_add_u32 s3, s3, s71
    buffer_load_dwordx4 v18, s[8:11], s3 offen lds
    s_add_u32 m0, s65, 1024
    s_add_u32 s3, s3, 10752
    buffer_load_dwordx4 v18, s[8:11], s3 offen lds
    s_add_u32 m0, s65, 2048
    s_add_u32 s3, s3, 10752
    buffer_load_dwordx4 v18, s[8:11], s3 offen lds
    s_add_u32 m0, s65, 3072
    s_add_u32 s3, s3, 10752
    buffer_load_dwordx4 v18, s[8:11], s3 offen lds
    s_add_u32 s67, s67, 1
    s_cmp_eq_u32 s67, 7
    s_cselect_b32 s67, 0, s67
    s_lshl_b32 s43, s67, 7
    s_add_u32 m0, s64, 24576
    s_add_u32 s43, s43, s70
    buffer_load_dwordx4 v16, s[4:7], s43 offen lds
    s_add_u32 m0, s64, 25600
    s_add_u32 s43, s43, 7168
    buffer_load_dwordx4 v17, s[4:7], s43 offen lds

    s_mul_i32 s3, s67, 172032
    s_add_u32 m0, s65, 24576
    s_add_u32 s3, s3, s71
    buffer_load_dwordx4 v18, s[8:11], s3 offen lds
    s_add_u32 m0, s65, 25600
    s_add_u32 s3, s3, 10752
    buffer_load_dwordx4 v18, s[8:11], s3 offen lds
    s_add_u32 m0, s65, 26624
    s_add_u32 s3, s3, 10752
    buffer_load_dwordx4 v18, s[8:11], s3 offen lds
    s_add_u32 m0, s65, 27648
    s_add_u32 s3, s3, 10752
    buffer_load_dwordx4 v18, s[8:11], s3 offen lds
    s_add_u32 s67, s67, 1
    s_cmp_eq_u32 s67, 7
    s_cselect_b32 s67, 0, s67
L_A_l0:
    s_mov_b32 s12, s54
    s_mov_b32 s13, s55
    s_mov_b32 s14, 9437184
    s_mov_b32 s15, 0x00020000

    s_mov_b32 s16, s48
    s_mov_b32 s17, s49
    s_mov_b32 s18, 401408
    s_mov_b32 s19, 0x00020000

    s_mov_b32 s20, s50
    s_mov_b32 s21, s51
    s_mov_b32 s22, 1835008
    s_mov_b32 s23, 0x00020000

    s_mov_b32 s24, s52
    s_mov_b32 s25, s53
    s_mov_b32 s26, 256
    s_mov_b32 s27, 0x00020000

    s_mov_b32 s38, 0
    s_mov_b32 s39, -1
    s_mov_b32 s40, 0x0fffffff
    s_mov_b32 s41, 0x0fffffff
    s_add_u32 s56, s30, 2
    s_and_b32 s56, s56, 3
    s_lshl_b32 s57, s32, 2
    s_add_u32 s56, s56, s57
    s_lshl_b32 s56, s56, 15
    s_lshl_b32 s57, s31, 11
    s_add_u32 s56, s56, s57
    s_lshl_b32 s57, s29, 10
    s_add_u32 s56, s56, s57
    s_add_u32 s68, s56, 6291456
    s_lshl_b32 s69, s32, 11
    s_add_u32 s69, s69, 8650752
    s_mov_b32 s37, 1073741824
    v_lshlrev_b32 v122, 4, v1
    v_mov_b32 v124, -1
    v_mov_b32 v125, -1
    v_mov_b32 v126, -1
    v_mov_b32 v127, -1
    buffer_store_dwordx4 v[124:127], v122, s[12:15], s68 offen sc1

    v_and_b32 v78, 31, v1
    v_cmp_eq_u32 vcc, 28, v78
    v_mov_b32 v78, 0
    v_mov_b32 v79, 0x3f803f80
    v_cndmask_b32 v78, v78, v79, vcc

    v_accvgpr_write_b32 a8, v78
    v_accvgpr_write_b32 a9, v78
    v_accvgpr_write_b32 a10, v78
    v_accvgpr_write_b32 a11, v78
    v_accvgpr_write_b32 a12, v78
    v_accvgpr_write_b32 a13, v78
    v_accvgpr_write_b32 a14, v78
    v_accvgpr_write_b32 a15, v78
    v_accvgpr_write_b32 a24, v78
    v_accvgpr_write_b32 a25, v78
    v_accvgpr_write_b32 a26, v78
    v_accvgpr_write_b32 a27, v78
    v_accvgpr_write_b32 a28, v78
    v_accvgpr_write_b32 a29, v78
    v_accvgpr_write_b32 a30, v78
    v_accvgpr_write_b32 a31, v78
    v_accvgpr_write_b32 a40, v78
    v_accvgpr_write_b32 a41, v78
    v_accvgpr_write_b32 a42, v78
    v_accvgpr_write_b32 a43, v78
    v_accvgpr_write_b32 a44, v78
    v_accvgpr_write_b32 a45, v78
    v_accvgpr_write_b32 a46, v78
    v_accvgpr_write_b32 a47, v78
    v_accvgpr_write_b32 a56, v78
    v_accvgpr_write_b32 a57, v78
    v_accvgpr_write_b32 a58, v78
    v_accvgpr_write_b32 a59, v78
    v_accvgpr_write_b32 a60, v78
    v_accvgpr_write_b32 a61, v78
    v_accvgpr_write_b32 a62, v78
    v_accvgpr_write_b32 a63, v78
    v_accvgpr_write_b32 a72, v78
    v_accvgpr_write_b32 a73, v78
    v_accvgpr_write_b32 a74, v78
    v_accvgpr_write_b32 a75, v78
    v_accvgpr_write_b32 a76, v78
    v_accvgpr_write_b32 a77, v78
    v_accvgpr_write_b32 a78, v78
    v_accvgpr_write_b32 a79, v78
    v_accvgpr_write_b32 a88, v78
    v_accvgpr_write_b32 a89, v78
    v_accvgpr_write_b32 a90, v78
    v_accvgpr_write_b32 a91, v78
    v_accvgpr_write_b32 a92, v78
    v_accvgpr_write_b32 a93, v78
    v_accvgpr_write_b32 a94, v78
    v_accvgpr_write_b32 a95, v78
    v_accvgpr_write_b32 a104, v78
    v_accvgpr_write_b32 a105, v78
    v_accvgpr_write_b32 a106, v78
    v_accvgpr_write_b32 a107, v78
    v_accvgpr_write_b32 a108, v78
    v_accvgpr_write_b32 a109, v78
    v_accvgpr_write_b32 a110, v78
    v_accvgpr_write_b32 a111, v78
    v_accvgpr_write_b32 a120, v78
    v_accvgpr_write_b32 a121, v78
    v_accvgpr_write_b32 a122, v78
    v_accvgpr_write_b32 a123, v78
    v_accvgpr_write_b32 a124, v78
    v_accvgpr_write_b32 a125, v78
    v_accvgpr_write_b32 a126, v78
    v_accvgpr_write_b32 a127, v78
    s_lshl_b32 s56, s32, 2
    s_add_u32 s56, s56, s30
    s_lshr_b32 s57, s56, 1
    s_and_b32 s59, s57, 15
    s_mul_i32 s58, s31, 28
    v_and_b32 v12, 1, v1
    v_mul_u32_u24 v12, 27, v12
    v_add_u32 v12, s58, v12
    v_lshrrev_b32 v12, 5, v12
    v_bfe_u32 v13, v1, 1, 1
    v_cmp_eq_u32 vcc, 1, v13
    v_mul_u32_u24 v13, 14, v13
    v_add_u32 v12, v12, v13
    v_mov_b32 v13, s57
    v_mov_b32 v9, s59
    v_cndmask_b32 v13, v13, v9, vcc
    v_lshl_add_u32 v12, v12, 5, v13
    s_and_b32 s59, s30, 1
    s_mul_i32 s59, s59, 27
    s_add_u32 s59, s59, s58
    s_lshr_b32 s59, s59, 5
    s_lshr_b32 s60, s30, 1
    s_mul_i32 s60, s60, 14
    s_add_u32 s59, s59, s60
    s_add_u32 s59, s59, 14
    s_lshl_b32 s59, s59, 5
    v_and_b32 v13, 15, v1
    v_add_u32 v13, s59, v13
    v_cmp_gt_u32 vcc, 16, v1
    s_lshl_b32 s54, s31, 17
    s_lshl_b32 s58, s56, 11
    v_cndmask_b32 v12, v13, v12, vcc
    v_lshlrev_b32 v12, 7, v12
    v_add_u32 v9, 8388608, v12
    s_add_u32 s54, s54, s58
    s_add_u32 s54, s54, 0
    s_lshl_b32 s55, s31, 18
    s_and_b32 s58, s56, 31
    s_lshl_b32 s58, s58, 12
    s_add_u32 s55, s55, s58
    s_add_u32 s55, s55, 2097152
    v_mov_b32 v8, 0

    s_lshl_b32 s42, s31, 18
    s_add_u32 s42, s42, 2097152
    s_lshl_b32 s44, s28, 14
    s_add_u32 s44, s44, s42

    s_add_u32 s45, s30, 0
    s_and_b32 s45, s45, 3
    s_add_u32 s46, s30, 1
    s_and_b32 s46, s46, 3
    s_add_u32 s47, s30, 3
    s_and_b32 s47, s47, 3
    s_add_u32 s48, s30, 2
    s_and_b32 s48, s48, 3
    s_and_b32 s66, s31, 3
    s_mul_i32 s66, s66, 224
    s_lshl_b32 s51, s28, 10
    s_add_u32 s51, s51, 61440
    s_cmp_eq_u32 s28, 7
    s_cselect_b32 s52, 28672, 0
    s_add_u32 s52, s52, s66

    s_add_u32 s56, s32, 0
    s_and_b32 s56, s56, 3
    s_lshl_b32 s56, s56, 12
    s_add_u32 s56, s56, s44
    s_add_u32 s60, s56, 131072
    s_add_u32 s57, s32, 1
    s_and_b32 s57, s57, 3
    s_lshl_b32 s57, s57, 12
    s_add_u32 s57, s57, s44
    s_add_u32 s61, s57, 131072
    s_add_u32 s58, s32, 2
    s_and_b32 s58, s58, 3
    s_lshl_b32 s58, s58, 12
    s_add_u32 s58, s58, s44
    s_add_u32 s62, s58, 131072
    s_add_u32 s59, s32, 3
    s_and_b32 s59, s59, 3
    s_lshl_b32 s59, s59, 12
    s_add_u32 s59, s59, s44
    s_add_u32 s63, s59, 131072
    s_mul_i32 s49, s31, 28
    v_and_b32 v32, 1, v1
    v_mul_u32_u24 v32, 27, v32
    v_add_u32 v32, s49, v32
    v_lshrrev_b32 v32, 5, v32
    v_bfe_u32 v33, v1, 1, 1
    v_mul_u32_u24 v33, 14, v33
    v_add3_u32 v32, v32, v33, 14
    v_bfe_u32 v33, v1, 2, 1
    v_lshl_add_u32 v32, v32, 5, v33
    s_lshl_b32 s49, s28, 1
    s_add_u32 s49, s49, 16
    v_add_u32 v32, s49, v32
    v_lshlrev_b32 v32, 7, v32
    v_add_u32 v7, 8388608, v32
    s_cmp_eq_u32 s28, 7
    s_cselect_b32 s49, 0, s28
    s_lshl_b32 s49, s49, 6
    v_add_u32 v32, s49, v1
    v_mul_u32_u24 v33, 586, v32
    v_lshrrev_b32 v33, 13, v33
    v_mul_u32_u24 v34, 14, v33
    v_sub_u32 v32, v32, v34
    v_mul_u32_u24 v33, 896, v33
    v_lshl_add_u32 v5, v32, 4, v33
    v_lshlrev_b32 v1, 4, v1
    s_lshl_b32 s43, s29, 14
    s_lshl_b32 s49, s45, 12
    s_add_u32 s49, s49, s43
    v_add_u32 v2, s49, v1
    s_lshl_b32 s49, s46, 12
    s_add_u32 s49, s49, s43
    s_add_u32 s49, s49, 32768
    v_add_u32 v3, s49, v1
    s_lshl_b32 s49, s47, 12
    s_add_u32 s49, s49, s43
    v_add_u32 v4, s49, v1
    s_lshl_b32 s49, s48, 12
    s_add_u32 s49, s49, s43
    v_add_u32 v6, s49, v1

    s_lshl_b32 s49, s45, 11
    s_add_u32 s49, s49, 65536
    v_add_u32 v72, s49, v1
    s_lshl_b32 s49, s46, 11
    s_add_u32 s49, s49, 65536
    v_add_u32 v73, s49, v1
    s_lshl_b32 s49, s47, 11
    s_add_u32 s49, s49, 65536
    v_add_u32 v74, s49, v1
    s_lshl_b32 s49, s48, 11
    s_add_u32 s49, s49, 65536
    v_add_u32 v75, s49, v1
    s_cmp_eq_u32 s33, 2
    s_cbranch_scc1 L_A_lidle
    s_waitcnt vmcnt(7)
    s_barrier
    s_lshl_b32 s43, s67, 7
    s_add_u32 m0, s64, 49152
    s_add_u32 s43, s43, s70
    buffer_load_dwordx4 v16, s[4:7], s43 offen lds
    s_add_u32 m0, s64, 50176
    s_add_u32 s43, s43, 7168
    buffer_load_dwordx4 v17, s[4:7], s43 offen lds

    s_mul_i32 s3, s67, 172032
    s_add_u32 m0, s65, 49152
    s_add_u32 s3, s3, s71
    buffer_load_dwordx4 v18, s[8:11], s3 offen lds
    s_add_u32 m0, s65, 50176
    s_add_u32 s3, s3, 10752
    buffer_load_dwordx4 v18, s[8:11], s3 offen lds
    s_add_u32 m0, s65, 51200
    s_add_u32 s3, s3, 10752
    buffer_load_dwordx4 v18, s[8:11], s3 offen lds
    s_add_u32 m0, s65, 52224
    s_add_u32 s3, s3, 10752
    buffer_load_dwordx4 v18, s[8:11], s3 offen lds
    s_add_u32 s67, s67, 1
    s_cmp_eq_u32 s67, 7
    s_cselect_b32 s67, 0, s67
    s_waitcnt vmcnt(7)
    s_barrier
    s_lshl_b32 s43, s67, 7
    s_add_u32 m0, s64, 73728
    s_add_u32 s43, s43, s70
    buffer_load_dwordx4 v16, s[4:7], s43 offen lds
    s_add_u32 m0, s64, 74752
    s_add_u32 s43, s43, 7168
    buffer_load_dwordx4 v17, s[4:7], s43 offen lds

    s_mul_i32 s3, s67, 172032
    s_add_u32 m0, s65, 73728
    s_add_u32 s3, s3, s71
    buffer_load_dwordx4 v18, s[8:11], s3 offen lds
    s_add_u32 m0, s65, 74752
    s_add_u32 s3, s3, 10752
    buffer_load_dwordx4 v18, s[8:11], s3 offen lds
    s_add_u32 m0, s65, 75776
    s_add_u32 s3, s3, 10752
    buffer_load_dwordx4 v18, s[8:11], s3 offen lds
    s_add_u32 m0, s65, 76800
    s_add_u32 s3, s3, 10752
    buffer_load_dwordx4 v18, s[8:11], s3 offen lds
    s_add_u32 s67, s67, 1
    s_cmp_eq_u32 s67, 7
    s_cselect_b32 s67, 0, s67
    s_waitcnt vmcnt(6)
    s_barrier
    s_lshl_b32 s43, s67, 7
    s_add_u32 m0, s64, 0
    s_add_u32 s43, s43, s70
    buffer_load_dwordx4 v16, s[4:7], s43 offen lds
    s_add_u32 m0, s64, 1024
    s_add_u32 s43, s43, 7168
    buffer_load_dwordx4 v17, s[4:7], s43 offen lds

    s_mul_i32 s3, s67, 172032
    s_add_u32 m0, s65, 0
    s_add_u32 s3, s3, s71
    buffer_load_dwordx4 v18, s[8:11], s3 offen lds
    s_add_u32 m0, s65, 1024
    s_add_u32 s3, s3, 10752
    buffer_load_dwordx4 v18, s[8:11], s3 offen lds
    s_add_u32 m0, s65, 2048
    s_add_u32 s3, s3, 10752
    buffer_load_dwordx4 v18, s[8:11], s3 offen lds
    s_add_u32 m0, s65, 3072
    s_add_u32 s3, s3, 10752
    buffer_load_dwordx4 v18, s[8:11], s3 offen lds
    s_add_u32 s67, s67, 1
    s_cmp_eq_u32 s67, 7
    s_cselect_b32 s67, 0, s67
    s_waitcnt vmcnt(6)
    s_barrier
    s_lshl_b32 s43, s67, 7
    s_add_u32 m0, s64, 24576
    s_add_u32 s43, s43, s70
    buffer_load_dwordx4 v16, s[4:7], s43 offen lds
    s_add_u32 m0, s64, 25600
    s_add_u32 s43, s43, 7168
    buffer_load_dwordx4 v17, s[4:7], s43 offen lds

    s_mul_i32 s3, s67, 172032
    s_add_u32 m0, s65, 24576
    s_add_u32 s3, s3, s71
    buffer_load_dwordx4 v18, s[8:11], s3 offen lds
    s_add_u32 m0, s65, 25600
    s_add_u32 s3, s3, 10752
    buffer_load_dwordx4 v18, s[8:11], s3 offen lds
    s_add_u32 m0, s65, 26624
    s_add_u32 s3, s3, 10752
    buffer_load_dwordx4 v18, s[8:11], s3 offen lds
    s_add_u32 m0, s65, 27648
    s_add_u32 s3, s3, 10752
    buffer_load_dwordx4 v18, s[8:11], s3 offen lds
    s_add_u32 s67, s67, 1
    s_cmp_eq_u32 s67, 7
    s_cselect_b32 s67, 0, s67
    s_waitcnt vmcnt(6)
    s_barrier
    s_lshl_b32 s43, s67, 7
    s_add_u32 m0, s64, 49152
    s_add_u32 s43, s43, s70
    buffer_load_dwordx4 v16, s[4:7], s43 offen lds
    s_add_u32 m0, s64, 50176
    s_add_u32 s43, s43, 7168
    buffer_load_dwordx4 v17, s[4:7], s43 offen lds

    s_mul_i32 s3, s67, 172032
    s_add_u32 m0, s65, 49152
    s_add_u32 s3, s3, s71
    buffer_load_dwordx4 v18, s[8:11], s3 offen lds
    s_add_u32 m0, s65, 50176
    s_add_u32 s3, s3, 10752
    buffer_load_dwordx4 v18, s[8:11], s3 offen lds
    s_add_u32 m0, s65, 51200
    s_add_u32 s3, s3, 10752
    buffer_load_dwordx4 v18, s[8:11], s3 offen lds
    s_add_u32 m0, s65, 52224
    s_add_u32 s3, s3, 10752
    buffer_load_dwordx4 v18, s[8:11], s3 offen lds
    s_add_u32 s67, s67, 1
    s_cmp_eq_u32 s67, 7
    s_cselect_b32 s67, 0, s67
    buffer_load_dwordx2 v[10:11], v8, s[24:27], 0 offen sc1
    s_cmp_eq_u32 s33, 1
    s_cbranch_scc1 L_A_lkv
    s_waitcnt vmcnt(7)
    s_barrier
    s_waitcnt vmcnt(0)
    s_barrier
    s_branch L_A_ldone

L_A_lkv:
    s_add_u32 s70, s70, 917504
    s_waitcnt vmcnt(7)
    s_barrier
    s_lshl_b32 s43, s67, 7
    s_add_u32 m0, s64, 98304
    s_add_u32 s43, s43, s70
    buffer_load_dwordx4 v16, s[4:7], s43 offen lds
    s_add_u32 m0, s64, 99328
    s_add_u32 s43, s43, 7168
    buffer_load_dwordx4 v17, s[4:7], s43 offen lds

    s_add_u32 s67, s67, 1
    s_cmp_eq_u32 s67, 7
    s_cselect_b32 s67, 0, s67
    s_lshl_b32 s43, s67, 7
    s_add_u32 m0, s64, 106496
    s_add_u32 s43, s43, s70
    buffer_load_dwordx4 v16, s[4:7], s43 offen lds
    s_add_u32 m0, s64, 107520
    s_add_u32 s43, s43, 7168
    buffer_load_dwordx4 v17, s[4:7], s43 offen lds

    s_add_u32 s67, s67, 1
    s_cmp_eq_u32 s67, 7
    s_cselect_b32 s67, 0, s67
    s_lshl_b32 s43, s67, 7
    s_add_u32 m0, s64, 114688
    s_add_u32 s43, s43, s70
    buffer_load_dwordx4 v16, s[4:7], s43 offen lds
    s_add_u32 m0, s64, 115712
    s_add_u32 s43, s43, 7168
    buffer_load_dwordx4 v17, s[4:7], s43 offen lds

    s_add_u32 s67, s67, 1
    s_cmp_eq_u32 s67, 7
    s_cselect_b32 s67, 0, s67
    s_waitcnt vmcnt(6)
    s_barrier
    s_waitcnt vmcnt(0)
    s_barrier
    s_lshl_b32 s43, s67, 7
    s_add_u32 m0, s64, 122880
    s_add_u32 s43, s43, s70
    buffer_load_dwordx4 v16, s[4:7], s43 offen lds
    s_add_u32 m0, s64, 123904
    s_add_u32 s43, s43, 7168
    buffer_load_dwordx4 v17, s[4:7], s43 offen lds

    s_add_u32 s67, s67, 1
    s_cmp_eq_u32 s67, 7
    s_cselect_b32 s67, 0, s67
    s_lshl_b32 s43, s67, 7
    s_add_u32 m0, s64, 131072
    s_add_u32 s43, s43, s70
    buffer_load_dwordx4 v16, s[4:7], s43 offen lds
    s_add_u32 m0, s64, 132096
    s_add_u32 s43, s43, 7168
    buffer_load_dwordx4 v17, s[4:7], s43 offen lds

    s_add_u32 s67, s67, 1
    s_cmp_eq_u32 s67, 7
    s_cselect_b32 s67, 0, s67
    s_lshl_b32 s43, s67, 7
    s_add_u32 m0, s64, 139264
    s_add_u32 s43, s43, s70
    buffer_load_dwordx4 v16, s[4:7], s43 offen lds
    s_add_u32 m0, s64, 140288
    s_add_u32 s43, s43, 7168
    buffer_load_dwordx4 v17, s[4:7], s43 offen lds

    s_add_u32 s67, s67, 1
    s_cmp_eq_u32 s67, 7
    s_cselect_b32 s67, 0, s67
    s_lshl_b32 s43, s67, 7
    s_add_u32 m0, s64, 147456
    s_add_u32 s43, s43, s70
    buffer_load_dwordx4 v16, s[4:7], s43 offen lds
    s_add_u32 m0, s64, 148480
    s_add_u32 s43, s43, 7168
    buffer_load_dwordx4 v17, s[4:7], s43 offen lds

    s_add_u32 s67, s67, 1
    s_cmp_eq_u32 s67, 7
    s_cselect_b32 s67, 0, s67
    s_waitcnt vmcnt(0)
    s_barrier
    s_branch L_A_ldone
L_A_lidle:
    buffer_load_dwordx2 v[10:11], v8, s[24:27], 0 offen sc1
    s_waitcnt vmcnt(0)
L_A_ldone:
    s_mov_b32 s3, 0
    v_cmp_eq_u32 vcc, 0, v10
    s_cbranch_vccz L_tok_done

L_tok:
    buffer_load_dwordx2 v[10:11], v8, s[24:27], 0 offen sc1
    s_add_u32 s3, s3, 1
    s_waitcnt vmcnt(0)
    v_cmp_eq_u32 vcc, 0, v10
    s_cmp_gt_u32 s3, 20000
    s_cbranch_scc1 L_tok_done
    s_cbranch_vccnz L_tok

L_tok_done:
    v_readfirstlane_b32 s36, v10
    s_mov_b32 s49, 0
    s_mov_b64 exec, 15
L_pollQ:
    buffer_load_dwordx2 v[14:15], v9, s[12:15], 0 offen sc1
    s_add_u32 s49, s49, 1
    s_waitcnt vmcnt(0)
    v_cmp_ne_u64 vcc, v[10:11], v[14:15]
    s_cmp_gt_u32 s49, 20000
    s_cbranch_scc1 L_pollQ_done
    s_and_b64 exec, exec, vcc
    s_cbranch_scc1 L_pollQ

L_pollQ_done:
    s_mov_b64 exec, -1
    buffer_load_dwordx4 v[104:107], v1, s[12:15], s55 offen sc1
    buffer_load_dwordx4 v[108:111], v1, s[12:15], s55 offen offset:1024 sc1
    buffer_load_dwordx4 v[16:19], v1, s[12:15], s54 offen sc1
    buffer_load_dwordx4 v[20:23], v1, s[12:15], s54 offen offset:1024 sc1

    s_mov_b32 s49, 0
    s_mov_b64 exec, 0xffff0000
L_pollA:
    buffer_load_dwordx2 v[14:15], v9, s[12:15], 0 offen sc1
    s_add_u32 s49, s49, 1
    s_waitcnt vmcnt(0)
    v_cmp_ne_u64 vcc, v[10:11], v[14:15]
    s_cmp_gt_u32 s49, 20000
    s_cbranch_scc1 L_pollA_done
    s_and_b64 exec, exec, vcc
    s_cbranch_scc1 L_pollA

L_pollA_done:
    s_mov_b64 exec, -1
    s_branch L_B1
L_A_cons:
    s_waitcnt lgkmcnt(0)
    s_mov_b32 s12, s54
    s_mov_b32 s13, s55
    s_mov_b32 s14, 9437184
    s_mov_b32 s15, 0x00020000

    s_mov_b32 s16, s48
    s_mov_b32 s17, s49
    s_mov_b32 s18, 401408
    s_mov_b32 s19, 0x00020000

    s_mov_b32 s20, s50
    s_mov_b32 s21, s51
    s_mov_b32 s22, 1835008
    s_mov_b32 s23, 0x00020000

    s_mov_b32 s24, s52
    s_mov_b32 s25, s53
    s_mov_b32 s26, 256
    s_mov_b32 s27, 0x00020000

    s_mov_b32 s38, 0
    s_mov_b32 s39, -1
    s_mov_b32 s40, 0x0fffffff
    s_mov_b32 s41, 0x0fffffff
    s_add_u32 s56, s30, 2
    s_and_b32 s56, s56, 3
    s_lshl_b32 s57, s32, 2
    s_add_u32 s56, s56, s57
    s_lshl_b32 s56, s56, 15
    s_lshl_b32 s57, s31, 11
    s_add_u32 s56, s56, s57
    s_lshl_b32 s57, s29, 10
    s_add_u32 s56, s56, s57
    s_add_u32 s68, s56, 6291456
    s_lshl_b32 s69, s32, 11
    s_add_u32 s69, s69, 8650752
    s_mov_b32 s37, 1073741824
    v_lshlrev_b32 v122, 4, v1
    v_mov_b32 v124, -1
    v_mov_b32 v125, -1
    v_mov_b32 v126, -1
    v_mov_b32 v127, -1
    buffer_store_dwordx4 v[124:127], v122, s[12:15], s68 offen sc1

    s_cmp_lg_u32 s2, 0
    s_cbranch_scc1 L_notok
    s_cmp_lg_u32 s30, 3
    s_cbranch_scc1 L_notok
    s_memrealtime s[56:57]
    s_waitcnt lgkmcnt(0)
    s_or_b32 s56, s56, 1
    v_mov_b32 v8, 0
    v_mov_b32 v10, s56
    v_mov_b32 v11, s57
    s_mov_b64 exec, 1
    buffer_store_dwordx2 v[10:11], v8, s[24:27], 0 offen sc1
    s_mov_b64 exec, -1

L_notok:
    v_mov_b32 v62, 0
    s_cmp_eq_u32 s33, 2
    s_cbranch_scc1 L_A_idle
    v_and_b32 v10, 31, v1
    v_lshrrev_b32 v11, 5, v1
    v_lshrrev_b32 v12, 3, v10
    v_and_b32 v13, 7, v10
    v_lshrrev_b32 v14, 1, v13
    v_and_b32 v15, 1, v12
    v_lshl_or_b32 v14, v15, 2, v14
    v_xor_b32 v14, v14, v11
    v_lshlrev_b32 v12, 10, v12
    v_lshl_add_u32 v12, v13, 7, v12

    v_xor_b32 v15, 0, v14
    v_lshl_add_u32 v5, v15, 4, v12
    v_xor_b32 v15, 2, v14
    v_lshl_add_u32 v6, v15, 4, v12
    v_xor_b32 v15, 4, v14
    v_lshl_add_u32 v7, v15, 4, v12
    v_xor_b32 v15, 6, v14
    v_lshl_add_u32 v8, v15, 4, v12
    v_bfe_u32 v10, v1, 4, 1
    v_bfe_u32 v12, v1, 2, 2
    v_bfe_u32 v13, v1, 1, 1
    v_lshl_add_u32 v13, v10, 1, v13
    s_lshl_b32 s56, s30, 2
    v_add_u32 v13, s56, v13
    v_lshlrev_b32 v14, 2, v12
    v_xor_b32 v13, v13, v14
    v_lshlrev_b32 v13, 4, v13
    v_lshl_add_u32 v13, v12, 8, v13
    v_lshl_add_u32 v13, v11, 11, v13
    v_and_b32 v14, 1, v1
    v_lshl_add_u32 v9, v14, 3, v13
    v_add_u32 v9, 8192, v9
    s_add_u32 s42, s34, s30
    s_lshl_b32 s56, s42, 5
    s_add_u32 s56, s56, s35
    s_lshl_b32 s56, s56, 7
    s_add_u32 s56, s56, 8388608
    s_add_u32 s57, s56, 2048
    s_cmp_eq_u32 s33, 1
    s_cselect_b32 s37, s57, 1073741824
    s_cselect_b32 s57, 42, 14
    s_cmp_ge_u32 s42, s57
    s_cselect_b32 s56, 1073741824, s56
    s_cselect_b32 s61, 1073741824, 0
    v_mov_b32 v63, s56
    s_cmp_ge_u32 s42, 28
    s_cbranch_scc1 L_A_vpath

    s_cmp_ge_u32 s42, 14
    s_cselect_b32 s43, 14, 0
    s_cselect_b32 s70, 1065353216, 1049335798
    s_cselect_b32 s71, 1065353216, 1049335798
    s_cselect_b32 s58, 2097152, 0
    s_cselect_b32 s57, 18, 17
    s_cselect_b32 s56, 13, 12
    s_sub_u32 s42, s42, s43
    s_lshl_b32 s42, s42, 2
    s_lshl_b32 s43, s35, s56
    s_add_u32 s58, s58, s43
    s_add_u32 s50, s58, s61
    s_sub_u32 s56, s56, 1
    s_lshl_b32 s56, 1, s56
    s_add_u32 s53, s50, s56
    s_lshl_b32 s67, 1, s57
    v_and_b32 v10, 31, v1
    v_lshlrev_b32 v10, 4, v10

    v_add_u32 v12, s42, v11
    v_add_u32 v12, 0, v12
    v_mul_u32_u24 v13, 147, v12
    v_lshrrev_b32 v13, 10, v13
    v_mul_u32_u24 v14, 7, v13
    v_sub_u32 v12, v12, v14
    v_lshrrev_b32 v14, 2, v12
    v_lshl_add_u32 v13, v13, 1, v14
    v_lshlrev_b32 v13, s57, v13
    v_add_u32 v13, v13, v10
    v_and_b32 v14, 3, v12
    v_lshl_add_u32 v64, v14, 9, v13
    v_cmp_eq_u32 s[54:55], 3, v12

    v_add_u32 v12, s42, v11
    v_add_u32 v12, 2, v12
    v_mul_u32_u24 v13, 147, v12
    v_lshrrev_b32 v13, 10, v13
    v_mul_u32_u24 v14, 7, v13
    v_sub_u32 v12, v12, v14
    v_lshrrev_b32 v14, 2, v12
    v_lshl_add_u32 v13, v13, 1, v14
    v_lshlrev_b32 v13, s57, v13
    v_add_u32 v13, v13, v10
    v_and_b32 v14, 3, v12
    v_lshl_add_u32 v65, v14, 9, v13
    v_cmp_eq_u32 s[64:65], 3, v12

    v_mov_b32 v68, 0x3f803f80
    v_mov_b32 v69, 0x00003f80
    v_mov_b32 v72, 0x3f803f80
    v_mov_b32 v73, 0x00003f80
    s_lshl_b32 s42, s31, 18
    s_add_u32 s42, s42, 2097152
    s_lshl_b32 s44, s28, 14
    s_add_u32 s44, s44, s42

    s_add_u32 s45, s30, 0
    s_and_b32 s45, s45, 3
    s_add_u32 s46, s30, 1
    s_and_b32 s46, s46, 3
    s_add_u32 s47, s30, 3
    s_and_b32 s47, s47, 3
    s_add_u32 s48, s30, 2
    s_and_b32 s48, s48, 3
    s_and_b32 s66, s31, 3
    s_mul_i32 s66, s66, 224
    s_lshl_b32 s51, s28, 10
    s_add_u32 s51, s51, 61440
    s_cmp_eq_u32 s28, 7
    s_cselect_b32 s52, 28672, 0
    s_add_u32 s52, s52, s66

    s_add_u32 s56, s32, 0
    s_and_b32 s56, s56, 3
    s_lshl_b32 s56, s56, 12
    s_add_u32 s56, s56, s44
    s_add_u32 s60, s56, 131072
    s_add_u32 s57, s32, 1
    s_and_b32 s57, s57, 3
    s_lshl_b32 s57, s57, 12
    s_add_u32 s57, s57, s44
    s_add_u32 s61, s57, 131072
    s_add_u32 s58, s32, 2
    s_and_b32 s58, s58, 3
    s_lshl_b32 s58, s58, 12
    s_add_u32 s58, s58, s44
    s_add_u32 s62, s58, 131072
    s_add_u32 s59, s32, 3
    s_and_b32 s59, s59, 3
    s_lshl_b32 s59, s59, 12
    s_add_u32 s59, s59, s44
    s_add_u32 s63, s59, 131072
    v_add_u32 v10, 0, v5
    v_add_u32 v11, 0, v6
    v_add_u32 v12, 0, v7
    v_add_u32 v13, 0, v8
    v_add_u32 v14, 0, v9
    s_barrier
    ds_read_b64_tr_b16 a[0:1], v14 offset:0
    ds_read_b64_tr_b16 a[2:3], v14 offset:1024
    ds_read_b128 v[16:19], v10
    ds_read_b128 v[20:23], v10 offset:4096
    ds_read_b64_tr_b16 a[4:5], v14 offset:4096
    ds_read_b64_tr_b16 a[6:7], v14 offset:5120
    ds_read_b128 v[24:27], v11
    ds_read_b128 v[28:31], v11 offset:4096
    s_waitcnt lgkmcnt(4)
    v_mfma_f32_32x32x16_bf16 v[80:95], a[0:3], v[16:19], 0
    ds_read_b64_tr_b16 a[8:9], v14 offset:8192
    ds_read_b64_tr_b16 a[10:11], v14 offset:9216
    v_mfma_f32_32x32x16_bf16 v[96:111], a[0:3], v[20:23], 0
    ds_read_b128 v[32:35], v12
    ds_read_b128 v[36:39], v12 offset:4096
    s_waitcnt lgkmcnt(4)
    v_mfma_f32_32x32x16_bf16 v[80:95], a[4:7], v[24:27], v[80:95]
    ds_read_b64_tr_b16 a[12:13], v14 offset:12288
    ds_read_b64_tr_b16 a[14:15], v14 offset:13312
    v_mfma_f32_32x32x16_bf16 v[96:111], a[4:7], v[28:31], v[96:111]
    ds_read_b128 v[16:19], v13
    ds_read_b128 v[20:23], v13 offset:4096
    s_waitcnt lgkmcnt(4)
    v_mfma_f32_32x32x16_bf16 v[80:95], a[8:11], v[32:35], v[80:95]
    v_mfma_f32_32x32x16_bf16 v[96:111], a[8:11], v[36:39], v[96:111]
    v_add_u32 v10, 24576, v5
    v_add_u32 v11, 24576, v6
    v_add_u32 v12, 24576, v7
    v_add_u32 v13, 24576, v8
    v_add_u32 v14, 24576, v9
    s_barrier
    ds_read_b64_tr_b16 a[16:17], v14 offset:0
    ds_read_b64_tr_b16 a[18:19], v14 offset:1024
    ds_read_b128 v[24:27], v10
    ds_read_b128 v[28:31], v10 offset:4096
    s_waitcnt lgkmcnt(4)
    v_mfma_f32_32x32x16_bf16 v[80:95], a[12:15], v[16:19], v[80:95]
    ds_read_b64_tr_b16 a[20:21], v14 offset:4096
    ds_read_b64_tr_b16 a[22:23], v14 offset:5120
    v_mfma_f32_32x32x16_bf16 v[96:111], a[12:15], v[20:23], v[96:111]
    ds_read_b128 v[32:35], v11
    ds_read_b128 v[36:39], v11 offset:4096
    s_waitcnt lgkmcnt(4)
    v_mfma_f32_32x32x16_bf16 v[80:95], a[16:19], v[24:27], v[80:95]
    ds_read_b64_tr_b16 a[24:25], v14 offset:8192
    ds_read_b64_tr_b16 a[26:27], v14 offset:9216
    v_mfma_f32_32x32x16_bf16 v[96:111], a[16:19], v[28:31], v[96:111]
    ds_read_b128 v[16:19], v12
    ds_read_b128 v[20:23], v12 offset:4096
    s_waitcnt lgkmcnt(4)
    v_mfma_f32_32x32x16_bf16 v[80:95], a[20:23], v[32:35], v[80:95]
    ds_read_b64_tr_b16 a[28:29], v14 offset:12288
    ds_read_b64_tr_b16 a[30:31], v14 offset:13312
    v_mfma_f32_32x32x16_bf16 v[96:111], a[20:23], v[36:39], v[96:111]
    ds_read_b128 v[24:27], v13
    ds_read_b128 v[28:31], v13 offset:4096
    s_waitcnt lgkmcnt(4)
    v_mfma_f32_32x32x16_bf16 v[80:95], a[24:27], v[16:19], v[80:95]
    v_mfma_f32_32x32x16_bf16 v[96:111], a[24:27], v[20:23], v[96:111]
    v_add_u32 v10, 49152, v5
    v_add_u32 v11, 49152, v6
    v_add_u32 v12, 49152, v7
    v_add_u32 v13, 49152, v8
    v_add_u32 v14, 49152, v9
    s_barrier
    ds_read_b64_tr_b16 a[32:33], v14 offset:0
    ds_read_b64_tr_b16 a[34:35], v14 offset:1024
    ds_read_b128 v[32:35], v10
    ds_read_b128 v[36:39], v10 offset:4096
    s_waitcnt lgkmcnt(4)
    v_mfma_f32_32x32x16_bf16 v[80:95], a[28:31], v[24:27], v[80:95]
    ds_read_b64_tr_b16 a[36:37], v14 offset:4096
    ds_read_b64_tr_b16 a[38:39], v14 offset:5120
    v_mfma_f32_32x32x16_bf16 v[96:111], a[28:31], v[28:31], v[96:111]
    ds_read_b128 v[16:19], v11
    ds_read_b128 v[20:23], v11 offset:4096
    s_waitcnt lgkmcnt(4)
    v_mfma_f32_32x32x16_bf16 v[80:95], a[32:35], v[32:35], v[80:95]
    ds_read_b64_tr_b16 a[40:41], v14 offset:8192
    ds_read_b64_tr_b16 a[42:43], v14 offset:9216
    v_mfma_f32_32x32x16_bf16 v[96:111], a[32:35], v[36:39], v[96:111]
    ds_read_b128 v[24:27], v12
    ds_read_b128 v[28:31], v12 offset:4096
    s_waitcnt lgkmcnt(4)
    v_mfma_f32_32x32x16_bf16 v[80:95], a[36:39], v[16:19], v[80:95]
    ds_read_b64_tr_b16 a[44:45], v14 offset:12288
    ds_read_b64_tr_b16 a[46:47], v14 offset:13312
    v_mfma_f32_32x32x16_bf16 v[96:111], a[36:39], v[20:23], v[96:111]
    ds_read_b128 v[32:35], v13
    ds_read_b128 v[36:39], v13 offset:4096
    s_waitcnt lgkmcnt(4)
    v_mfma_f32_32x32x16_bf16 v[80:95], a[40:43], v[24:27], v[80:95]
    v_mfma_f32_32x32x16_bf16 v[96:111], a[40:43], v[28:31], v[96:111]
    v_add_u32 v10, 73728, v5
    v_add_u32 v11, 73728, v6
    v_add_u32 v12, 73728, v7
    v_add_u32 v13, 73728, v8
    v_add_u32 v14, 73728, v9
    s_barrier
    ds_read_b64_tr_b16 a[48:49], v14 offset:0
    ds_read_b64_tr_b16 a[50:51], v14 offset:1024
    ds_read_b128 v[16:19], v10
    ds_read_b128 v[20:23], v10 offset:4096
    s_waitcnt lgkmcnt(4)
    v_mfma_f32_32x32x16_bf16 v[80:95], a[44:47], v[32:35], v[80:95]
    ds_read_b64_tr_b16 a[52:53], v14 offset:4096
    ds_read_b64_tr_b16 a[54:55], v14 offset:5120
    v_mfma_f32_32x32x16_bf16 v[96:111], a[44:47], v[36:39], v[96:111]
    ds_read_b128 v[24:27], v11
    ds_read_b128 v[28:31], v11 offset:4096
    s_waitcnt lgkmcnt(4)
    v_mfma_f32_32x32x16_bf16 v[80:95], a[48:51], v[16:19], v[80:95]
    ds_read_b64_tr_b16 a[56:57], v14 offset:8192
    ds_read_b64_tr_b16 a[58:59], v14 offset:9216
    v_mfma_f32_32x32x16_bf16 v[96:111], a[48:51], v[20:23], v[96:111]
    ds_read_b128 v[32:35], v12
    ds_read_b128 v[36:39], v12 offset:4096
    s_waitcnt lgkmcnt(4)
    v_mfma_f32_32x32x16_bf16 v[80:95], a[52:55], v[24:27], v[80:95]
    ds_read_b64_tr_b16 a[60:61], v14 offset:12288
    ds_read_b64_tr_b16 a[62:63], v14 offset:13312
    v_mfma_f32_32x32x16_bf16 v[96:111], a[52:55], v[28:31], v[96:111]
    ds_read_b128 v[16:19], v13
    ds_read_b128 v[20:23], v13 offset:4096
    s_waitcnt lgkmcnt(4)
    v_mfma_f32_32x32x16_bf16 v[80:95], a[56:59], v[32:35], v[80:95]
    v_mfma_f32_32x32x16_bf16 v[96:111], a[56:59], v[36:39], v[96:111]
    v_add_u32 v10, 0, v5
    v_add_u32 v11, 0, v6
    v_add_u32 v12, 0, v7
    v_add_u32 v13, 0, v8
    v_add_u32 v14, 0, v9
    s_barrier
    ds_read_b64_tr_b16 a[64:65], v14 offset:0
    ds_read_b64_tr_b16 a[66:67], v14 offset:1024
    ds_read_b128 v[24:27], v10
    ds_read_b128 v[28:31], v10 offset:4096
    s_waitcnt lgkmcnt(4)
    v_mfma_f32_32x32x16_bf16 v[80:95], a[60:63], v[16:19], v[80:95]
    ds_read_b64_tr_b16 a[68:69], v14 offset:4096
    ds_read_b64_tr_b16 a[70:71], v14 offset:5120
    v_mfma_f32_32x32x16_bf16 v[96:111], a[60:63], v[20:23], v[96:111]
    ds_read_b128 v[32:35], v11
    ds_read_b128 v[36:39], v11 offset:4096
    s_waitcnt lgkmcnt(4)
    v_mfma_f32_32x32x16_bf16 v[80:95], a[64:67], v[24:27], v[80:95]
    ds_read_b64_tr_b16 a[72:73], v14 offset:8192
    ds_read_b64_tr_b16 a[74:75], v14 offset:9216
    v_mfma_f32_32x32x16_bf16 v[96:111], a[64:67], v[28:31], v[96:111]
    ds_read_b128 v[16:19], v12
    ds_read_b128 v[20:23], v12 offset:4096
    s_waitcnt lgkmcnt(4)
    v_mfma_f32_32x32x16_bf16 v[80:95], a[68:71], v[32:35], v[80:95]
    ds_read_b64_tr_b16 a[76:77], v14 offset:12288
    ds_read_b64_tr_b16 a[78:79], v14 offset:13312
    v_mfma_f32_32x32x16_bf16 v[96:111], a[68:71], v[36:39], v[96:111]
    ds_read_b128 v[24:27], v13
    ds_read_b128 v[28:31], v13 offset:4096
    s_waitcnt lgkmcnt(4)
    v_mfma_f32_32x32x16_bf16 v[80:95], a[72:75], v[16:19], v[80:95]
    v_mfma_f32_32x32x16_bf16 v[96:111], a[72:75], v[20:23], v[96:111]
    v_add_u32 v10, 24576, v5
    v_add_u32 v11, 24576, v6
    v_add_u32 v12, 24576, v7
    v_add_u32 v13, 24576, v8
    v_add_u32 v14, 24576, v9
    s_barrier
    ds_read_b64_tr_b16 a[80:81], v14 offset:0
    ds_read_b64_tr_b16 a[82:83], v14 offset:1024
    ds_read_b128 v[32:35], v10
    ds_read_b128 v[36:39], v10 offset:4096
    s_waitcnt lgkmcnt(4)
    v_mfma_f32_32x32x16_bf16 v[80:95], a[76:79], v[24:27], v[80:95]
    ds_read_b64_tr_b16 a[84:85], v14 offset:4096
    ds_read_b64_tr_b16 a[86:87], v14 offset:5120
    v_mfma_f32_32x32x16_bf16 v[96:111], a[76:79], v[28:31], v[96:111]
    ds_read_b128 v[16:19], v11
    ds_read_b128 v[20:23], v11 offset:4096
    s_waitcnt lgkmcnt(4)
    v_mfma_f32_32x32x16_bf16 v[80:95], a[80:83], v[32:35], v[80:95]
    ds_read_b64_tr_b16 a[88:89], v14 offset:8192
    ds_read_b64_tr_b16 a[90:91], v14 offset:9216
    v_mfma_f32_32x32x16_bf16 v[96:111], a[80:83], v[36:39], v[96:111]
    ds_read_b128 v[24:27], v12
    ds_read_b128 v[28:31], v12 offset:4096
    s_waitcnt lgkmcnt(4)
    v_mfma_f32_32x32x16_bf16 v[80:95], a[84:87], v[16:19], v[80:95]
    ds_read_b64_tr_b16 a[92:93], v14 offset:12288
    ds_read_b64_tr_b16 a[94:95], v14 offset:13312
    v_mfma_f32_32x32x16_bf16 v[96:111], a[84:87], v[20:23], v[96:111]
    ds_read_b128 v[32:35], v13
    ds_read_b128 v[36:39], v13 offset:4096
    s_waitcnt lgkmcnt(4)
    v_mfma_f32_32x32x16_bf16 v[80:95], a[88:91], v[24:27], v[80:95]
    v_mfma_f32_32x32x16_bf16 v[96:111], a[88:91], v[28:31], v[96:111]
    v_add_u32 v10, 49152, v5
    v_add_u32 v11, 49152, v6
    v_add_u32 v12, 49152, v7
    v_add_u32 v13, 49152, v8
    v_add_u32 v14, 49152, v9
    s_barrier
    buffer_load_dwordx2 v[60:61], v62, s[24:27], 0 offen sc1
    ds_read_b64_tr_b16 a[96:97], v14 offset:0
    ds_read_b64_tr_b16 a[98:99], v14 offset:1024
    ds_read_b128 v[16:19], v10
    ds_read_b128 v[20:23], v10 offset:4096
    s_waitcnt lgkmcnt(4)
    v_mfma_f32_32x32x16_bf16 v[80:95], a[92:95], v[32:35], v[80:95]
    ds_read_b64_tr_b16 a[100:101], v14 offset:4096
    ds_read_b64_tr_b16 a[102:103], v14 offset:5120
    v_mfma_f32_32x32x16_bf16 v[96:111], a[92:95], v[36:39], v[96:111]
    ds_read_b128 v[24:27], v11
    ds_read_b128 v[28:31], v11 offset:4096
    s_waitcnt lgkmcnt(4)
    v_mfma_f32_32x32x16_bf16 v[80:95], a[96:99], v[16:19], v[80:95]
    ds_read_b64_tr_b16 a[104:105], v14 offset:8192
    ds_read_b64_tr_b16 a[106:107], v14 offset:9216
    v_mfma_f32_32x32x16_bf16 v[96:111], a[96:99], v[20:23], v[96:111]
    ds_read_b128 v[32:35], v12
    ds_read_b128 v[36:39], v12 offset:4096
    s_waitcnt lgkmcnt(4)
    v_mfma_f32_32x32x16_bf16 v[80:95], a[100:103], v[24:27], v[80:95]
    ds_read_b64_tr_b16 a[108:109], v14 offset:12288
    ds_read_b64_tr_b16 a[110:111], v14 offset:13312
    v_mfma_f32_32x32x16_bf16 v[96:111], a[100:103], v[28:31], v[96:111]
    ds_read_b128 v[16:19], v13
    ds_read_b128 v[20:23], v13 offset:4096
    s_waitcnt lgkmcnt(4)
    v_mfma_f32_32x32x16_bf16 v[80:95], a[104:107], v[32:35], v[80:95]
    v_mfma_f32_32x32x16_bf16 v[96:111], a[104:107], v[36:39], v[96:111]
    s_waitcnt lgkmcnt(0)
    v_mfma_f32_32x32x16_bf16 v[80:95], a[108:111], v[16:19], v[80:95]
    v_mfma_f32_32x32x16_bf16 v[96:111], a[108:111], v[20:23], v[96:111]
    s_nop 7
    s_nop 2
    v_pk_mul_f32 v[80:81], v[80:81], s[70:71]
    v_pk_mul_f32 v[82:83], v[82:83], s[70:71]
    v_pk_mul_f32 v[84:85], v[84:85], s[70:71]
    v_pk_mul_f32 v[86:87], v[86:87], s[70:71]
    v_cvt_pk_bf16_f32 v40, v80, v81
    v_cvt_pk_bf16_f32 v41, v82, v83
    v_cvt_pk_bf16_f32 v42, v84, v85
    v_cvt_pk_bf16_f32 v43, v86, v87
    s_add_u32 s3, s50, s67
    s_nop 0
    v_permlane32_swap_b32 v40, v42
    v_permlane32_swap_b32 v41, v43
    s_mov_b64 exec, s[54:55]
    v_mov_b32 v66, v42
    v_mov_b32 v67, v43
    v_mov_b32 v42, v68
    v_mov_b32 v43, v69
    buffer_store_dwordx4 v[66:69], v64, s[12:15], s3 offen sc1
    s_mov_b64 exec, -1
    buffer_store_dwordx4 v[40:43], v64, s[12:15], s50 offen sc1
    v_pk_mul_f32 v[88:89], v[88:89], s[70:71]
    v_pk_mul_f32 v[90:91], v[90:91], s[70:71]
    v_pk_mul_f32 v[92:93], v[92:93], s[70:71]
    v_pk_mul_f32 v[94:95], v[94:95], s[70:71]
    v_cvt_pk_bf16_f32 v44, v88, v89
    v_cvt_pk_bf16_f32 v45, v90, v91
    v_cvt_pk_bf16_f32 v46, v92, v93
    v_cvt_pk_bf16_f32 v47, v94, v95
    s_add_u32 s3, s50, s67
    s_nop 0
    v_permlane32_swap_b32 v44, v46
    v_permlane32_swap_b32 v45, v47
    s_mov_b64 exec, s[64:65]
    v_mov_b32 v66, v46
    v_mov_b32 v67, v47
    v_mov_b32 v46, v68
    v_mov_b32 v47, v69
    buffer_store_dwordx4 v[66:69], v65, s[12:15], s3 offen sc1
    s_mov_b64 exec, -1
    buffer_store_dwordx4 v[44:47], v65, s[12:15], s50 offen sc1
    v_pk_mul_f32 v[96:97], v[96:97], s[70:71]
    v_pk_mul_f32 v[98:99], v[98:99], s[70:71]
    v_pk_mul_f32 v[100:101], v[100:101], s[70:71]
    v_pk_mul_f32 v[102:103], v[102:103], s[70:71]
    v_cvt_pk_bf16_f32 v48, v96, v97
    v_cvt_pk_bf16_f32 v49, v98, v99
    v_cvt_pk_bf16_f32 v50, v100, v101
    v_cvt_pk_bf16_f32 v51, v102, v103
    s_add_u32 s3, s53, s67
    s_nop 0
    v_permlane32_swap_b32 v48, v50
    v_permlane32_swap_b32 v49, v51
    s_mov_b64 exec, s[54:55]
    v_mov_b32 v70, v50
    v_mov_b32 v71, v51
    v_mov_b32 v50, v72
    v_mov_b32 v51, v73
    buffer_store_dwordx4 v[70:73], v64, s[12:15], s3 offen sc1
    s_mov_b64 exec, -1
    buffer_store_dwordx4 v[48:51], v64, s[12:15], s53 offen sc1
    v_pk_mul_f32 v[104:105], v[104:105], s[70:71]
    v_pk_mul_f32 v[106:107], v[106:107], s[70:71]
    v_pk_mul_f32 v[108:109], v[108:109], s[70:71]
    v_pk_mul_f32 v[110:111], v[110:111], s[70:71]
    v_cvt_pk_bf16_f32 v52, v104, v105
    v_cvt_pk_bf16_f32 v53, v106, v107
    v_cvt_pk_bf16_f32 v54, v108, v109
    v_cvt_pk_bf16_f32 v55, v110, v111
    s_add_u32 s3, s53, s67
    s_nop 0
    v_permlane32_swap_b32 v52, v54
    v_permlane32_swap_b32 v53, v55
    s_mov_b64 exec, s[64:65]
    v_mov_b32 v70, v54
    v_mov_b32 v71, v55
    v_mov_b32 v54, v72
    v_mov_b32 v55, v73
    buffer_store_dwordx4 v[70:73], v65, s[12:15], s3 offen sc1
    s_mov_b64 exec, -1
    buffer_store_dwordx4 v[52:55], v65, s[12:15], s53 offen sc1
    s_cmp_eq_u32 s33, 0
    s_cbranch_scc1 L_A_qdone
    s_barrier
    v_add_u32 v10, 98304, v5
    v_add_u32 v11, 98304, v6
    v_add_u32 v12, 98304, v7
    v_add_u32 v13, 98304, v8
    s_add_u32 s50, s50, 131072
    s_add_u32 s53, s53, 131072
    v_and_b32 v78, 31, v1
    v_cmp_eq_u32 vcc, 28, v78
    v_mov_b32 v78, 0
    v_mov_b32 v79, 0x3f803f80
    v_cndmask_b32 v78, v78, v79, vcc

    ds_read_b128 v[16:19], v10 offset:0
    ds_read_b128 v[20:23], v10 offset:4096
    ds_read_b128 v[24:27], v11 offset:0
    ds_read_b128 v[28:31], v11 offset:4096
    s_waitcnt lgkmcnt(2)
    v_mfma_f32_32x32x16_bf16 v[80:95], a[0:3], v[16:19], 0
    ds_read_b128 v[32:35], v12 offset:0
    v_mfma_f32_32x32x16_bf16 v[96:111], a[0:3], v[20:23], 0
    ds_read_b128 v[36:39], v12 offset:4096
    s_waitcnt lgkmcnt(2)
    v_mfma_f32_32x32x16_bf16 v[80:95], a[4:7], v[24:27], v[80:95]
    ds_read_b128 v[16:19], v13 offset:0
    v_mfma_f32_32x32x16_bf16 v[96:111], a[4:7], v[28:31], v[96:111]
    ds_read_b128 v[20:23], v13 offset:4096
    s_waitcnt lgkmcnt(2)
    v_mfma_f32_32x32x16_bf16 v[80:95], a[8:11], v[32:35], v[80:95]
    ds_read_b128 v[24:27], v10 offset:8192
    v_mfma_f32_32x32x16_bf16 v[96:111], a[8:11], v[36:39], v[96:111]
    ds_read_b128 v[28:31], v10 offset:12288
    s_waitcnt lgkmcnt(2)
    v_mfma_f32_32x32x16_bf16 v[80:95], a[12:15], v[16:19], v[80:95]
    ds_read_b128 v[32:35], v11 offset:8192
    v_accvgpr_write_b32 a8, v78
    v_accvgpr_write_b32 a9, v78
    v_mfma_f32_32x32x16_bf16 v[96:111], a[12:15], v[20:23], v[96:111]
    ds_read_b128 v[36:39], v11 offset:12288
    v_accvgpr_write_b32 a10, v78
    v_accvgpr_write_b32 a11, v78
    s_waitcnt lgkmcnt(2)
    v_mfma_f32_32x32x16_bf16 v[80:95], a[16:19], v[24:27], v[80:95]
    ds_read_b128 v[16:19], v12 offset:8192
    v_accvgpr_write_b32 a12, v78
    v_accvgpr_write_b32 a13, v78
    v_mfma_f32_32x32x16_bf16 v[96:111], a[16:19], v[28:31], v[96:111]
    ds_read_b128 v[20:23], v12 offset:12288
    v_accvgpr_write_b32 a14, v78
    v_accvgpr_write_b32 a15, v78
    s_waitcnt lgkmcnt(2)
    v_mfma_f32_32x32x16_bf16 v[80:95], a[20:23], v[32:35], v[80:95]
    ds_read_b128 v[24:27], v13 offset:8192
    v_mfma_f32_32x32x16_bf16 v[96:111], a[20:23], v[36:39], v[96:111]
    ds_read_b128 v[28:31], v13 offset:12288
    s_waitcnt lgkmcnt(2)
    v_mfma_f32_32x32x16_bf16 v[80:95], a[24:27], v[16:19], v[80:95]
    ds_read_b128 v[32:35], v10 offset:16384
    v_mfma_f32_32x32x16_bf16 v[96:111], a[24:27], v[20:23], v[96:111]
    ds_read_b128 v[36:39], v10 offset:20480
    s_waitcnt lgkmcnt(2)
    v_mfma_f32_32x32x16_bf16 v[80:95], a[28:31], v[24:27], v[80:95]
    ds_read_b128 v[16:19], v11 offset:16384
    v_accvgpr_write_b32 a24, v78
    v_accvgpr_write_b32 a25, v78
    v_mfma_f32_32x32x16_bf16 v[96:111], a[28:31], v[28:31], v[96:111]
    ds_read_b128 v[20:23], v11 offset:20480
    v_accvgpr_write_b32 a26, v78
    v_accvgpr_write_b32 a27, v78
    s_waitcnt lgkmcnt(2)
    v_mfma_f32_32x32x16_bf16 v[80:95], a[32:35], v[32:35], v[80:95]
    ds_read_b128 v[24:27], v12 offset:16384
    v_accvgpr_write_b32 a28, v78
    v_accvgpr_write_b32 a29, v78
    v_mfma_f32_32x32x16_bf16 v[96:111], a[32:35], v[36:39], v[96:111]
    ds_read_b128 v[28:31], v12 offset:20480
    v_accvgpr_write_b32 a30, v78
    v_accvgpr_write_b32 a31, v78
    s_waitcnt lgkmcnt(2)
    v_mfma_f32_32x32x16_bf16 v[80:95], a[36:39], v[16:19], v[80:95]
    ds_read_b128 v[32:35], v13 offset:16384
    v_mfma_f32_32x32x16_bf16 v[96:111], a[36:39], v[20:23], v[96:111]
    ds_read_b128 v[36:39], v13 offset:20480
    s_waitcnt lgkmcnt(2)
    v_mfma_f32_32x32x16_bf16 v[80:95], a[40:43], v[24:27], v[80:95]
    v_mfma_f32_32x32x16_bf16 v[96:111], a[40:43], v[28:31], v[96:111]
    s_waitcnt lgkmcnt(0)
    v_mfma_f32_32x32x16_bf16 v[80:95], a[44:47], v[32:35], v[80:95]
    v_accvgpr_write_b32 a40, v78
    v_accvgpr_write_b32 a41, v78
    v_mfma_f32_32x32x16_bf16 v[96:111], a[44:47], v[36:39], v[96:111]
    v_accvgpr_write_b32 a42, v78
    v_accvgpr_write_b32 a43, v78
    s_waitcnt vmcnt(0)
    s_mov_b32 s3, 0
    v_cmp_eq_u32 vcc, 0, v60
    s_cbranch_vccz L_Ak_tok_done

L_Ak_tok:
    buffer_load_dwordx2 v[60:61], v62, s[24:27], 0 offen sc1
    s_add_u32 s3, s3, 1
    s_waitcnt vmcnt(0)
    v_cmp_eq_u32 vcc, 0, v60
    s_cmp_gt_u32 s3, 20000
    s_cbranch_scc1 L_Ak_tok_done
    s_cbranch_vccnz L_Ak_tok

L_Ak_tok_done:
    s_mov_b64 exec, 1
    buffer_store_dwordx2 v[60:61], v63, s[12:15], 0 offen sc1
    s_mov_b64 exec, -1
    v_readfirstlane_b32 s36, v60

    s_barrier
    ds_read_b128 v[16:19], v10 offset:24576
    ds_read_b128 v[20:23], v10 offset:28672
    ds_read_b128 v[24:27], v11 offset:24576
    ds_read_b128 v[28:31], v11 offset:28672
    s_waitcnt lgkmcnt(2)
    v_mfma_f32_32x32x16_bf16 v[80:95], a[48:51], v[16:19], v[80:95]
    ds_read_b128 v[32:35], v12 offset:24576
    v_accvgpr_write_b32 a44, v78
    v_accvgpr_write_b32 a45, v78
    v_mfma_f32_32x32x16_bf16 v[96:111], a[48:51], v[20:23], v[96:111]
    ds_read_b128 v[36:39], v12 offset:28672
    v_accvgpr_write_b32 a46, v78
    v_accvgpr_write_b32 a47, v78
    s_waitcnt lgkmcnt(2)
    v_mfma_f32_32x32x16_bf16 v[80:95], a[52:55], v[24:27], v[80:95]
    ds_read_b128 v[16:19], v13 offset:24576
    v_mfma_f32_32x32x16_bf16 v[96:111], a[52:55], v[28:31], v[96:111]
    ds_read_b128 v[20:23], v13 offset:28672
    s_waitcnt lgkmcnt(2)
    v_mfma_f32_32x32x16_bf16 v[80:95], a[56:59], v[32:35], v[80:95]
    ds_read_b128 v[24:27], v10 offset:32768
    v_mfma_f32_32x32x16_bf16 v[96:111], a[56:59], v[36:39], v[96:111]
    ds_read_b128 v[28:31], v10 offset:36864
    s_waitcnt lgkmcnt(2)
    v_mfma_f32_32x32x16_bf16 v[80:95], a[60:63], v[16:19], v[80:95]
    ds_read_b128 v[32:35], v11 offset:32768
    v_accvgpr_write_b32 a56, v78
    v_accvgpr_write_b32 a57, v78
    v_mfma_f32_32x32x16_bf16 v[96:111], a[60:63], v[20:23], v[96:111]
    ds_read_b128 v[36:39], v11 offset:36864
    v_accvgpr_write_b32 a58, v78
    v_accvgpr_write_b32 a59, v78
    s_waitcnt lgkmcnt(2)
    v_mfma_f32_32x32x16_bf16 v[80:95], a[64:67], v[24:27], v[80:95]
    ds_read_b128 v[16:19], v12 offset:32768
    v_accvgpr_write_b32 a60, v78
    v_accvgpr_write_b32 a61, v78
    v_mfma_f32_32x32x16_bf16 v[96:111], a[64:67], v[28:31], v[96:111]
    ds_read_b128 v[20:23], v12 offset:36864
    v_accvgpr_write_b32 a62, v78
    v_accvgpr_write_b32 a63, v78
    s_waitcnt lgkmcnt(2)
    v_mfma_f32_32x32x16_bf16 v[80:95], a[68:71], v[32:35], v[80:95]
    ds_read_b128 v[24:27], v13 offset:32768
    v_mfma_f32_32x32x16_bf16 v[96:111], a[68:71], v[36:39], v[96:111]
    ds_read_b128 v[28:31], v13 offset:36864
    s_waitcnt lgkmcnt(2)
    v_mfma_f32_32x32x16_bf16 v[80:95], a[72:75], v[16:19], v[80:95]
    ds_read_b128 v[32:35], v10 offset:40960
    v_mfma_f32_32x32x16_bf16 v[96:111], a[72:75], v[20:23], v[96:111]
    ds_read_b128 v[36:39], v10 offset:45056
    s_waitcnt lgkmcnt(2)
    v_mfma_f32_32x32x16_bf16 v[80:95], a[76:79], v[24:27], v[80:95]
    ds_read_b128 v[16:19], v11 offset:40960
    v_accvgpr_write_b32 a72, v78
    v_accvgpr_write_b32 a73, v78
    v_mfma_f32_32x32x16_bf16 v[96:111], a[76:79], v[28:31], v[96:111]
    ds_read_b128 v[20:23], v11 offset:45056
    v_accvgpr_write_b32 a74, v78
    v_accvgpr_write_b32 a75, v78
    s_waitcnt lgkmcnt(2)
    v_mfma_f32_32x32x16_bf16 v[80:95], a[80:83], v[32:35], v[80:95]
    ds_read_b128 v[24:27], v12 offset:40960
    v_accvgpr_write_b32 a76, v78
    v_accvgpr_write_b32 a77, v78
    v_mfma_f32_32x32x16_bf16 v[96:111], a[80:83], v[36:39], v[96:111]
    ds_read_b128 v[28:31], v12 offset:45056
    v_accvgpr_write_b32 a78, v78
    v_accvgpr_write_b32 a79, v78
    s_waitcnt lgkmcnt(2)
    v_mfma_f32_32x32x16_bf16 v[80:95], a[84:87], v[16:19], v[80:95]
    ds_read_b128 v[32:35], v13 offset:40960
    v_mfma_f32_32x32x16_bf16 v[96:111], a[84:87], v[20:23], v[96:111]
    ds_read_b128 v[36:39], v13 offset:45056
    s_waitcnt lgkmcnt(2)
    v_mfma_f32_32x32x16_bf16 v[80:95], a[88:91], v[24:27], v[80:95]
    ds_read_b128 v[16:19], v10 offset:49152
    v_mfma_f32_32x32x16_bf16 v[96:111], a[88:91], v[28:31], v[96:111]
    ds_read_b128 v[20:23], v10 offset:53248
    s_waitcnt lgkmcnt(2)
    v_mfma_f32_32x32x16_bf16 v[80:95], a[92:95], v[32:35], v[80:95]
    ds_read_b128 v[24:27], v11 offset:49152
    v_accvgpr_write_b32 a88, v78
    v_accvgpr_write_b32 a89, v78
    v_mfma_f32_32x32x16_bf16 v[96:111], a[92:95], v[36:39], v[96:111]
    ds_read_b128 v[28:31], v11 offset:53248
    v_accvgpr_write_b32 a90, v78
    v_accvgpr_write_b32 a91, v78
    s_waitcnt lgkmcnt(2)
    v_mfma_f32_32x32x16_bf16 v[80:95], a[96:99], v[16:19], v[80:95]
    ds_read_b128 v[32:35], v12 offset:49152
    v_accvgpr_write_b32 a92, v78
    v_accvgpr_write_b32 a93, v78
    v_mfma_f32_32x32x16_bf16 v[96:111], a[96:99], v[20:23], v[96:111]
    ds_read_b128 v[36:39], v12 offset:53248
    v_accvgpr_write_b32 a94, v78
    v_accvgpr_write_b32 a95, v78
    s_waitcnt lgkmcnt(2)
    v_mfma_f32_32x32x16_bf16 v[80:95], a[100:103], v[24:27], v[80:95]
    ds_read_b128 v[16:19], v13 offset:49152
    v_mfma_f32_32x32x16_bf16 v[96:111], a[100:103], v[28:31], v[96:111]
    ds_read_b128 v[20:23], v13 offset:53248
    s_waitcnt lgkmcnt(2)
    v_mfma_f32_32x32x16_bf16 v[80:95], a[104:107], v[32:35], v[80:95]
    v_mfma_f32_32x32x16_bf16 v[96:111], a[104:107], v[36:39], v[96:111]
    s_waitcnt lgkmcnt(0)
    v_mfma_f32_32x32x16_bf16 v[80:95], a[108:111], v[16:19], v[80:95]
    v_accvgpr_write_b32 a104, v78
    v_accvgpr_write_b32 a105, v78
    v_mfma_f32_32x32x16_bf16 v[96:111], a[108:111], v[20:23], v[96:111]
    v_accvgpr_write_b32 a106, v78
    v_accvgpr_write_b32 a107, v78
    v_accvgpr_write_b32 a108, v78
    v_accvgpr_write_b32 a109, v78
    v_accvgpr_write_b32 a110, v78
    v_accvgpr_write_b32 a111, v78
    v_accvgpr_write_b32 a120, v78
    v_accvgpr_write_b32 a121, v78
    v_accvgpr_write_b32 a122, v78
    v_accvgpr_write_b32 a123, v78
    v_accvgpr_write_b32 a124, v78
    v_accvgpr_write_b32 a125, v78
    v_accvgpr_write_b32 a126, v78
    v_accvgpr_write_b32 a127, v78
    v_pk_mul_f32 v[80:81], v[80:81], s[70:71]
    v_pk_mul_f32 v[82:83], v[82:83], s[70:71]
    v_pk_mul_f32 v[84:85], v[84:85], s[70:71]
    v_pk_mul_f32 v[86:87], v[86:87], s[70:71]
    v_cvt_pk_bf16_f32 v40, v80, v81
    v_cvt_pk_bf16_f32 v41, v82, v83
    v_cvt_pk_bf16_f32 v42, v84, v85
    v_cvt_pk_bf16_f32 v43, v86, v87
    s_add_u32 s3, s50, s67
    s_nop 0
    v_permlane32_swap_b32 v40, v42
    v_permlane32_swap_b32 v41, v43
    s_mov_b64 exec, s[54:55]
    v_mov_b32 v66, v42
    v_mov_b32 v67, v43
    v_mov_b32 v42, v68
    v_mov_b32 v43, v69
    buffer_store_dwordx4 v[66:69], v64, s[12:15], s3 offen sc1
    s_mov_b64 exec, -1
    buffer_store_dwordx4 v[40:43], v64, s[12:15], s50 offen sc1
    v_pk_mul_f32 v[88:89], v[88:89], s[70:71]
    v_pk_mul_f32 v[90:91], v[90:91], s[70:71]
    v_pk_mul_f32 v[92:93], v[92:93], s[70:71]
    v_pk_mul_f32 v[94:95], v[94:95], s[70:71]
    v_cvt_pk_bf16_f32 v44, v88, v89
    v_cvt_pk_bf16_f32 v45, v90, v91
    v_cvt_pk_bf16_f32 v46, v92, v93
    v_cvt_pk_bf16_f32 v47, v94, v95
    s_add_u32 s3, s50, s67
    s_nop 0
    v_permlane32_swap_b32 v44, v46
    v_permlane32_swap_b32 v45, v47
    s_mov_b64 exec, s[64:65]
    v_mov_b32 v66, v46
    v_mov_b32 v67, v47
    v_mov_b32 v46, v68
    v_mov_b32 v47, v69
    buffer_store_dwordx4 v[66:69], v65, s[12:15], s3 offen sc1
    s_mov_b64 exec, -1
    buffer_store_dwordx4 v[44:47], v65, s[12:15], s50 offen sc1
    v_pk_mul_f32 v[96:97], v[96:97], s[70:71]
    v_pk_mul_f32 v[98:99], v[98:99], s[70:71]
    v_pk_mul_f32 v[100:101], v[100:101], s[70:71]
    v_pk_mul_f32 v[102:103], v[102:103], s[70:71]
    v_cvt_pk_bf16_f32 v48, v96, v97
    v_cvt_pk_bf16_f32 v49, v98, v99
    v_cvt_pk_bf16_f32 v50, v100, v101
    v_cvt_pk_bf16_f32 v51, v102, v103
    s_add_u32 s3, s53, s67
    s_nop 0
    v_permlane32_swap_b32 v48, v50
    v_permlane32_swap_b32 v49, v51
    s_mov_b64 exec, s[54:55]
    v_mov_b32 v70, v50
    v_mov_b32 v71, v51
    v_mov_b32 v50, v72
    v_mov_b32 v51, v73
    buffer_store_dwordx4 v[70:73], v64, s[12:15], s3 offen sc1
    s_mov_b64 exec, -1
    buffer_store_dwordx4 v[48:51], v64, s[12:15], s53 offen sc1
    v_pk_mul_f32 v[104:105], v[104:105], s[70:71]
    v_pk_mul_f32 v[106:107], v[106:107], s[70:71]
    v_pk_mul_f32 v[108:109], v[108:109], s[70:71]
    v_pk_mul_f32 v[110:111], v[110:111], s[70:71]
    v_cvt_pk_bf16_f32 v52, v104, v105
    v_cvt_pk_bf16_f32 v53, v106, v107
    v_cvt_pk_bf16_f32 v54, v108, v109
    v_cvt_pk_bf16_f32 v55, v110, v111
    s_add_u32 s3, s53, s67
    s_nop 0
    v_permlane32_swap_b32 v52, v54
    v_permlane32_swap_b32 v53, v55
    s_mov_b64 exec, s[64:65]
    v_mov_b32 v70, v54
    v_mov_b32 v71, v55
    v_mov_b32 v54, v72
    v_mov_b32 v55, v73
    buffer_store_dwordx4 v[70:73], v65, s[12:15], s3 offen sc1
    s_mov_b64 exec, -1
    buffer_store_dwordx4 v[52:55], v65, s[12:15], s53 offen sc1
    s_branch L_A_cdone
L_A_vpath:
    s_lshl_b32 s58, s35, 13
    s_add_u32 s50, s58, 2099200
    s_add_u32 s53, s50, 4096
    s_sub_u32 s42, s42, 28
    s_lshl_b32 s42, s42, 5
    v_and_b32 v10, 31, v1
    v_add_u32 v10, s42, v10
    v_mul_u32_u24 v12, 293, v10
    v_lshrrev_b32 v12, 13, v12
    v_mul_u32_u24 v13, 28, v12
    v_sub_u32 v10, v10, v13
    v_lshlrev_b32 v12, 18, v12
    v_lshl_add_u32 v12, v10, 4, v12
    v_lshl_add_u32 v64, v11, 9, v12

    s_lshl_b32 s42, s31, 18
    s_add_u32 s42, s42, 2097152
    s_lshl_b32 s44, s28, 14
    s_add_u32 s44, s44, s42

    s_add_u32 s45, s30, 0
    s_and_b32 s45, s45, 3
    s_add_u32 s46, s30, 1
    s_and_b32 s46, s46, 3
    s_add_u32 s47, s30, 3
    s_and_b32 s47, s47, 3
    s_add_u32 s48, s30, 2
    s_and_b32 s48, s48, 3
    s_and_b32 s66, s31, 3
    s_mul_i32 s66, s66, 224
    s_lshl_b32 s51, s28, 10
    s_add_u32 s51, s51, 61440
    s_cmp_eq_u32 s28, 7
    s_cselect_b32 s52, 28672, 0
    s_add_u32 s52, s52, s66

    s_add_u32 s56, s32, 0
    s_and_b32 s56, s56, 3
    s_lshl_b32 s56, s56, 12
    s_add_u32 s56, s56, s44
    s_add_u32 s60, s56, 131072
    s_add_u32 s57, s32, 1
    s_and_b32 s57, s57, 3
    s_lshl_b32 s57, s57, 12
    s_add_u32 s57, s57, s44
    s_add_u32 s61, s57, 131072
    s_add_u32 s58, s32, 2
    s_and_b32 s58, s58, 3
    s_lshl_b32 s58, s58, 12
    s_add_u32 s58, s58, s44
    s_add_u32 s62, s58, 131072
    s_add_u32 s59, s32, 3
    s_and_b32 s59, s59, 3
    s_lshl_b32 s59, s59, 12
    s_add_u32 s59, s59, s44
    s_add_u32 s63, s59, 131072
    v_add_u32 v10, 0, v5
    v_add_u32 v11, 0, v6
    v_add_u32 v12, 0, v7
    v_add_u32 v13, 0, v8
    v_add_u32 v14, 0, v9
    s_barrier
    ds_read_b64_tr_b16 a[0:1], v14 offset:0
    ds_read_b64_tr_b16 a[2:3], v14 offset:1024
    ds_read_b128 v[16:19], v10
    ds_read_b128 v[20:23], v10 offset:4096
    ds_read_b64_tr_b16 a[4:5], v14 offset:4096
    ds_read_b64_tr_b16 a[6:7], v14 offset:5120
    ds_read_b128 v[24:27], v11
    ds_read_b128 v[28:31], v11 offset:4096
    s_waitcnt lgkmcnt(4)
    v_mfma_f32_32x32x16_bf16 v[80:95], v[16:19], a[0:3], 0
    ds_read_b64_tr_b16 a[8:9], v14 offset:8192
    ds_read_b64_tr_b16 a[10:11], v14 offset:9216
    v_mfma_f32_32x32x16_bf16 v[96:111], v[20:23], a[0:3], 0
    ds_read_b128 v[32:35], v12
    ds_read_b128 v[36:39], v12 offset:4096
    s_waitcnt lgkmcnt(4)
    v_mfma_f32_32x32x16_bf16 v[80:95], v[24:27], a[4:7], v[80:95]
    ds_read_b64_tr_b16 a[12:13], v14 offset:12288
    ds_read_b64_tr_b16 a[14:15], v14 offset:13312
    v_mfma_f32_32x32x16_bf16 v[96:111], v[28:31], a[4:7], v[96:111]
    ds_read_b128 v[16:19], v13
    ds_read_b128 v[20:23], v13 offset:4096
    s_waitcnt lgkmcnt(4)
    v_mfma_f32_32x32x16_bf16 v[80:95], v[32:35], a[8:11], v[80:95]
    v_mfma_f32_32x32x16_bf16 v[96:111], v[36:39], a[8:11], v[96:111]
    v_add_u32 v10, 24576, v5
    v_add_u32 v11, 24576, v6
    v_add_u32 v12, 24576, v7
    v_add_u32 v13, 24576, v8
    v_add_u32 v14, 24576, v9
    s_barrier
    ds_read_b64_tr_b16 a[16:17], v14 offset:0
    ds_read_b64_tr_b16 a[18:19], v14 offset:1024
    ds_read_b128 v[24:27], v10
    ds_read_b128 v[28:31], v10 offset:4096
    s_waitcnt lgkmcnt(4)
    v_mfma_f32_32x32x16_bf16 v[80:95], v[16:19], a[12:15], v[80:95]
    ds_read_b64_tr_b16 a[20:21], v14 offset:4096
    ds_read_b64_tr_b16 a[22:23], v14 offset:5120
    v_mfma_f32_32x32x16_bf16 v[96:111], v[20:23], a[12:15], v[96:111]
    ds_read_b128 v[32:35], v11
    ds_read_b128 v[36:39], v11 offset:4096
    s_waitcnt lgkmcnt(4)
    v_mfma_f32_32x32x16_bf16 v[80:95], v[24:27], a[16:19], v[80:95]
    ds_read_b64_tr_b16 a[24:25], v14 offset:8192
    ds_read_b64_tr_b16 a[26:27], v14 offset:9216
    v_mfma_f32_32x32x16_bf16 v[96:111], v[28:31], a[16:19], v[96:111]
    ds_read_b128 v[16:19], v12
    ds_read_b128 v[20:23], v12 offset:4096
    s_waitcnt lgkmcnt(4)
    v_mfma_f32_32x32x16_bf16 v[80:95], v[32:35], a[20:23], v[80:95]
    ds_read_b64_tr_b16 a[28:29], v14 offset:12288
    ds_read_b64_tr_b16 a[30:31], v14 offset:13312
    v_mfma_f32_32x32x16_bf16 v[96:111], v[36:39], a[20:23], v[96:111]
    ds_read_b128 v[24:27], v13
    ds_read_b128 v[28:31], v13 offset:4096
    s_waitcnt lgkmcnt(4)
    v_mfma_f32_32x32x16_bf16 v[80:95], v[16:19], a[24:27], v[80:95]
    v_mfma_f32_32x32x16_bf16 v[96:111], v[20:23], a[24:27], v[96:111]
    v_add_u32 v10, 49152, v5
    v_add_u32 v11, 49152, v6
    v_add_u32 v12, 49152, v7
    v_add_u32 v13, 49152, v8
    v_add_u32 v14, 49152, v9
    s_barrier
    ds_read_b64_tr_b16 a[32:33], v14 offset:0
    ds_read_b64_tr_b16 a[34:35], v14 offset:1024
    ds_read_b128 v[32:35], v10
    ds_read_b128 v[36:39], v10 offset:4096
    s_waitcnt lgkmcnt(4)
    v_mfma_f32_32x32x16_bf16 v[80:95], v[24:27], a[28:31], v[80:95]
    ds_read_b64_tr_b16 a[36:37], v14 offset:4096
    ds_read_b64_tr_b16 a[38:39], v14 offset:5120
    v_mfma_f32_32x32x16_bf16 v[96:111], v[28:31], a[28:31], v[96:111]
    ds_read_b128 v[16:19], v11
    ds_read_b128 v[20:23], v11 offset:4096
    s_waitcnt lgkmcnt(4)
    v_mfma_f32_32x32x16_bf16 v[80:95], v[32:35], a[32:35], v[80:95]
    ds_read_b64_tr_b16 a[40:41], v14 offset:8192
    ds_read_b64_tr_b16 a[42:43], v14 offset:9216
    v_mfma_f32_32x32x16_bf16 v[96:111], v[36:39], a[32:35], v[96:111]
    ds_read_b128 v[24:27], v12
    ds_read_b128 v[28:31], v12 offset:4096
    s_waitcnt lgkmcnt(4)
    v_mfma_f32_32x32x16_bf16 v[80:95], v[16:19], a[36:39], v[80:95]
    ds_read_b64_tr_b16 a[44:45], v14 offset:12288
    ds_read_b64_tr_b16 a[46:47], v14 offset:13312
    v_mfma_f32_32x32x16_bf16 v[96:111], v[20:23], a[36:39], v[96:111]
    ds_read_b128 v[32:35], v13
    ds_read_b128 v[36:39], v13 offset:4096
    s_waitcnt lgkmcnt(4)
    v_mfma_f32_32x32x16_bf16 v[80:95], v[24:27], a[40:43], v[80:95]
    v_mfma_f32_32x32x16_bf16 v[96:111], v[28:31], a[40:43], v[96:111]
    v_add_u32 v10, 73728, v5
    v_add_u32 v11, 73728, v6
    v_add_u32 v12, 73728, v7
    v_add_u32 v13, 73728, v8
    v_add_u32 v14, 73728, v9
    s_barrier
    ds_read_b64_tr_b16 a[48:49], v14 offset:0
    ds_read_b64_tr_b16 a[50:51], v14 offset:1024
    ds_read_b128 v[16:19], v10
    ds_read_b128 v[20:23], v10 offset:4096
    s_waitcnt lgkmcnt(4)
    v_mfma_f32_32x32x16_bf16 v[80:95], v[32:35], a[44:47], v[80:95]
    ds_read_b64_tr_b16 a[52:53], v14 offset:4096
    ds_read_b64_tr_b16 a[54:55], v14 offset:5120
    v_mfma_f32_32x32x16_bf16 v[96:111], v[36:39], a[44:47], v[96:111]
    ds_read_b128 v[24:27], v11
    ds_read_b128 v[28:31], v11 offset:4096
    s_waitcnt lgkmcnt(4)
    v_mfma_f32_32x32x16_bf16 v[80:95], v[16:19], a[48:51], v[80:95]
    ds_read_b64_tr_b16 a[56:57], v14 offset:8192
    ds_read_b64_tr_b16 a[58:59], v14 offset:9216
    v_mfma_f32_32x32x16_bf16 v[96:111], v[20:23], a[48:51], v[96:111]
    ds_read_b128 v[32:35], v12
    ds_read_b128 v[36:39], v12 offset:4096
    s_waitcnt lgkmcnt(4)
    v_mfma_f32_32x32x16_bf16 v[80:95], v[24:27], a[52:55], v[80:95]
    ds_read_b64_tr_b16 a[60:61], v14 offset:12288
    ds_read_b64_tr_b16 a[62:63], v14 offset:13312
    v_mfma_f32_32x32x16_bf16 v[96:111], v[28:31], a[52:55], v[96:111]
    ds_read_b128 v[16:19], v13
    ds_read_b128 v[20:23], v13 offset:4096
    s_waitcnt lgkmcnt(4)
    v_mfma_f32_32x32x16_bf16 v[80:95], v[32:35], a[56:59], v[80:95]
    v_mfma_f32_32x32x16_bf16 v[96:111], v[36:39], a[56:59], v[96:111]
    v_add_u32 v10, 0, v5
    v_add_u32 v11, 0, v6
    v_add_u32 v12, 0, v7
    v_add_u32 v13, 0, v8
    v_add_u32 v14, 0, v9
    s_barrier
    ds_read_b64_tr_b16 a[64:65], v14 offset:0
    ds_read_b64_tr_b16 a[66:67], v14 offset:1024
    ds_read_b128 v[24:27], v10
    ds_read_b128 v[28:31], v10 offset:4096
    s_waitcnt lgkmcnt(4)
    v_mfma_f32_32x32x16_bf16 v[80:95], v[16:19], a[60:63], v[80:95]
    ds_read_b64_tr_b16 a[68:69], v14 offset:4096
    ds_read_b64_tr_b16 a[70:71], v14 offset:5120
    v_mfma_f32_32x32x16_bf16 v[96:111], v[20:23], a[60:63], v[96:111]
    ds_read_b128 v[32:35], v11
    ds_read_b128 v[36:39], v11 offset:4096
    s_waitcnt lgkmcnt(4)
    v_mfma_f32_32x32x16_bf16 v[80:95], v[24:27], a[64:67], v[80:95]
    ds_read_b64_tr_b16 a[72:73], v14 offset:8192
    ds_read_b64_tr_b16 a[74:75], v14 offset:9216
    v_mfma_f32_32x32x16_bf16 v[96:111], v[28:31], a[64:67], v[96:111]
    ds_read_b128 v[16:19], v12
    ds_read_b128 v[20:23], v12 offset:4096
    s_waitcnt lgkmcnt(4)
    v_mfma_f32_32x32x16_bf16 v[80:95], v[32:35], a[68:71], v[80:95]
    ds_read_b64_tr_b16 a[76:77], v14 offset:12288
    ds_read_b64_tr_b16 a[78:79], v14 offset:13312
    v_mfma_f32_32x32x16_bf16 v[96:111], v[36:39], a[68:71], v[96:111]
    ds_read_b128 v[24:27], v13
    ds_read_b128 v[28:31], v13 offset:4096
    s_waitcnt lgkmcnt(4)
    v_mfma_f32_32x32x16_bf16 v[80:95], v[16:19], a[72:75], v[80:95]
    v_mfma_f32_32x32x16_bf16 v[96:111], v[20:23], a[72:75], v[96:111]
    v_add_u32 v10, 24576, v5
    v_add_u32 v11, 24576, v6
    v_add_u32 v12, 24576, v7
    v_add_u32 v13, 24576, v8
    v_add_u32 v14, 24576, v9
    s_barrier
    ds_read_b64_tr_b16 a[80:81], v14 offset:0
    ds_read_b64_tr_b16 a[82:83], v14 offset:1024
    ds_read_b128 v[32:35], v10
    ds_read_b128 v[36:39], v10 offset:4096
    s_waitcnt lgkmcnt(4)
    v_mfma_f32_32x32x16_bf16 v[80:95], v[24:27], a[76:79], v[80:95]
    ds_read_b64_tr_b16 a[84:85], v14 offset:4096
    ds_read_b64_tr_b16 a[86:87], v14 offset:5120
    v_mfma_f32_32x32x16_bf16 v[96:111], v[28:31], a[76:79], v[96:111]
    ds_read_b128 v[16:19], v11
    ds_read_b128 v[20:23], v11 offset:4096
    s_waitcnt lgkmcnt(4)
    v_mfma_f32_32x32x16_bf16 v[80:95], v[32:35], a[80:83], v[80:95]
    ds_read_b64_tr_b16 a[88:89], v14 offset:8192
    ds_read_b64_tr_b16 a[90:91], v14 offset:9216
    v_mfma_f32_32x32x16_bf16 v[96:111], v[36:39], a[80:83], v[96:111]
    ds_read_b128 v[24:27], v12
    ds_read_b128 v[28:31], v12 offset:4096
    s_waitcnt lgkmcnt(4)
    v_mfma_f32_32x32x16_bf16 v[80:95], v[16:19], a[84:87], v[80:95]
    ds_read_b64_tr_b16 a[92:93], v14 offset:12288
    ds_read_b64_tr_b16 a[94:95], v14 offset:13312
    v_mfma_f32_32x32x16_bf16 v[96:111], v[20:23], a[84:87], v[96:111]
    ds_read_b128 v[32:35], v13
    ds_read_b128 v[36:39], v13 offset:4096
    s_waitcnt lgkmcnt(4)
    v_mfma_f32_32x32x16_bf16 v[80:95], v[24:27], a[88:91], v[80:95]
    v_mfma_f32_32x32x16_bf16 v[96:111], v[28:31], a[88:91], v[96:111]
    v_add_u32 v10, 49152, v5
    v_add_u32 v11, 49152, v6
    v_add_u32 v12, 49152, v7
    v_add_u32 v13, 49152, v8
    v_add_u32 v14, 49152, v9
    s_barrier
    buffer_load_dwordx2 v[60:61], v62, s[24:27], 0 offen sc1
    ds_read_b64_tr_b16 a[96:97], v14 offset:0
    ds_read_b64_tr_b16 a[98:99], v14 offset:1024
    ds_read_b128 v[16:19], v10
    ds_read_b128 v[20:23], v10 offset:4096
    s_waitcnt lgkmcnt(4)
    v_mfma_f32_32x32x16_bf16 v[80:95], v[32:35], a[92:95], v[80:95]
    ds_read_b64_tr_b16 a[100:101], v14 offset:4096
    ds_read_b64_tr_b16 a[102:103], v14 offset:5120
    v_mfma_f32_32x32x16_bf16 v[96:111], v[36:39], a[92:95], v[96:111]
    ds_read_b128 v[24:27], v11
    ds_read_b128 v[28:31], v11 offset:4096
    s_waitcnt lgkmcnt(4)
    v_mfma_f32_32x32x16_bf16 v[80:95], v[16:19], a[96:99], v[80:95]
    ds_read_b64_tr_b16 a[104:105], v14 offset:8192
    ds_read_b64_tr_b16 a[106:107], v14 offset:9216
    v_mfma_f32_32x32x16_bf16 v[96:111], v[20:23], a[96:99], v[96:111]
    ds_read_b128 v[32:35], v12
    ds_read_b128 v[36:39], v12 offset:4096
    s_waitcnt lgkmcnt(4)
    v_mfma_f32_32x32x16_bf16 v[80:95], v[24:27], a[100:103], v[80:95]
    ds_read_b64_tr_b16 a[108:109], v14 offset:12288
    ds_read_b64_tr_b16 a[110:111], v14 offset:13312
    v_mfma_f32_32x32x16_bf16 v[96:111], v[28:31], a[100:103], v[96:111]
    ds_read_b128 v[16:19], v13
    ds_read_b128 v[20:23], v13 offset:4096
    s_waitcnt lgkmcnt(4)
    v_mfma_f32_32x32x16_bf16 v[80:95], v[32:35], a[104:107], v[80:95]
    v_mfma_f32_32x32x16_bf16 v[96:111], v[36:39], a[104:107], v[96:111]
    s_waitcnt lgkmcnt(0)
    v_mfma_f32_32x32x16_bf16 v[80:95], v[16:19], a[108:111], v[80:95]
    v_mfma_f32_32x32x16_bf16 v[96:111], v[20:23], a[108:111], v[96:111]
    s_nop 7
    s_nop 2
    v_cvt_pk_bf16_f32 v40, v80, v81
    v_cvt_pk_bf16_f32 v41, v82, v83
    v_cvt_pk_bf16_f32 v42, v84, v85
    v_cvt_pk_bf16_f32 v43, v86, v87
    buffer_store_dwordx4 v[40:43], v64, s[12:15], s50 offen offset:0 sc1
    v_cvt_pk_bf16_f32 v44, v88, v89
    v_cvt_pk_bf16_f32 v45, v90, v91
    v_cvt_pk_bf16_f32 v46, v92, v93
    v_cvt_pk_bf16_f32 v47, v94, v95
    buffer_store_dwordx4 v[44:47], v64, s[12:15], s50 offen offset:1024 sc1
    v_cvt_pk_bf16_f32 v48, v96, v97
    v_cvt_pk_bf16_f32 v49, v98, v99
    v_cvt_pk_bf16_f32 v50, v100, v101
    v_cvt_pk_bf16_f32 v51, v102, v103
    buffer_store_dwordx4 v[48:51], v64, s[12:15], s53 offen offset:0 sc1
    v_cvt_pk_bf16_f32 v52, v104, v105
    v_cvt_pk_bf16_f32 v53, v106, v107
    v_cvt_pk_bf16_f32 v54, v108, v109
    v_cvt_pk_bf16_f32 v55, v110, v111
    buffer_store_dwordx4 v[52:55], v64, s[12:15], s53 offen offset:1024 sc1
    s_cmp_eq_u32 s33, 0
    s_cbranch_scc1 L_A_qdone
    s_barrier
    v_add_u32 v10, 98304, v5
    v_add_u32 v11, 98304, v6
    v_add_u32 v12, 98304, v7
    v_add_u32 v13, 98304, v8
    s_add_u32 s50, s50, 131072
    s_add_u32 s53, s53, 131072
    v_and_b32 v78, 31, v1
    v_cmp_eq_u32 vcc, 28, v78
    v_mov_b32 v78, 0
    v_mov_b32 v79, 0x3f803f80
    v_cndmask_b32 v78, v78, v79, vcc

    ds_read_b128 v[16:19], v10 offset:0
    ds_read_b128 v[20:23], v10 offset:4096
    ds_read_b128 v[24:27], v11 offset:0
    ds_read_b128 v[28:31], v11 offset:4096
    s_waitcnt lgkmcnt(2)
    v_mfma_f32_32x32x16_bf16 v[80:95], v[16:19], a[0:3], 0
    ds_read_b128 v[32:35], v12 offset:0
    v_mfma_f32_32x32x16_bf16 v[96:111], v[20:23], a[0:3], 0
    ds_read_b128 v[36:39], v12 offset:4096
    s_waitcnt lgkmcnt(2)
    v_mfma_f32_32x32x16_bf16 v[80:95], v[24:27], a[4:7], v[80:95]
    ds_read_b128 v[16:19], v13 offset:0
    v_mfma_f32_32x32x16_bf16 v[96:111], v[28:31], a[4:7], v[96:111]
    ds_read_b128 v[20:23], v13 offset:4096
    s_waitcnt lgkmcnt(2)
    v_mfma_f32_32x32x16_bf16 v[80:95], v[32:35], a[8:11], v[80:95]
    ds_read_b128 v[24:27], v10 offset:8192
    v_mfma_f32_32x32x16_bf16 v[96:111], v[36:39], a[8:11], v[96:111]
    ds_read_b128 v[28:31], v10 offset:12288
    s_waitcnt lgkmcnt(2)
    v_mfma_f32_32x32x16_bf16 v[80:95], v[16:19], a[12:15], v[80:95]
    ds_read_b128 v[32:35], v11 offset:8192
    v_accvgpr_write_b32 a8, v78
    v_accvgpr_write_b32 a9, v78
    v_mfma_f32_32x32x16_bf16 v[96:111], v[20:23], a[12:15], v[96:111]
    ds_read_b128 v[36:39], v11 offset:12288
    v_accvgpr_write_b32 a10, v78
    v_accvgpr_write_b32 a11, v78
    s_waitcnt lgkmcnt(2)
    v_mfma_f32_32x32x16_bf16 v[80:95], v[24:27], a[16:19], v[80:95]
    ds_read_b128 v[16:19], v12 offset:8192
    v_accvgpr_write_b32 a12, v78
    v_accvgpr_write_b32 a13, v78
    v_mfma_f32_32x32x16_bf16 v[96:111], v[28:31], a[16:19], v[96:111]
    ds_read_b128 v[20:23], v12 offset:12288
    v_accvgpr_write_b32 a14, v78
    v_accvgpr_write_b32 a15, v78
    s_waitcnt lgkmcnt(2)
    v_mfma_f32_32x32x16_bf16 v[80:95], v[32:35], a[20:23], v[80:95]
    ds_read_b128 v[24:27], v13 offset:8192
    v_mfma_f32_32x32x16_bf16 v[96:111], v[36:39], a[20:23], v[96:111]
    ds_read_b128 v[28:31], v13 offset:12288
    s_waitcnt lgkmcnt(2)
    v_mfma_f32_32x32x16_bf16 v[80:95], v[16:19], a[24:27], v[80:95]
    ds_read_b128 v[32:35], v10 offset:16384
    v_mfma_f32_32x32x16_bf16 v[96:111], v[20:23], a[24:27], v[96:111]
    ds_read_b128 v[36:39], v10 offset:20480
    s_waitcnt lgkmcnt(2)
    v_mfma_f32_32x32x16_bf16 v[80:95], v[24:27], a[28:31], v[80:95]
    ds_read_b128 v[16:19], v11 offset:16384
    v_accvgpr_write_b32 a24, v78
    v_accvgpr_write_b32 a25, v78
    v_mfma_f32_32x32x16_bf16 v[96:111], v[28:31], a[28:31], v[96:111]
    ds_read_b128 v[20:23], v11 offset:20480
    v_accvgpr_write_b32 a26, v78
    v_accvgpr_write_b32 a27, v78
    s_waitcnt lgkmcnt(2)
    v_mfma_f32_32x32x16_bf16 v[80:95], v[32:35], a[32:35], v[80:95]
    ds_read_b128 v[24:27], v12 offset:16384
    v_accvgpr_write_b32 a28, v78
    v_accvgpr_write_b32 a29, v78
    v_mfma_f32_32x32x16_bf16 v[96:111], v[36:39], a[32:35], v[96:111]
    ds_read_b128 v[28:31], v12 offset:20480
    v_accvgpr_write_b32 a30, v78
    v_accvgpr_write_b32 a31, v78
    s_waitcnt lgkmcnt(2)
    v_mfma_f32_32x32x16_bf16 v[80:95], v[16:19], a[36:39], v[80:95]
    ds_read_b128 v[32:35], v13 offset:16384
    v_mfma_f32_32x32x16_bf16 v[96:111], v[20:23], a[36:39], v[96:111]
    ds_read_b128 v[36:39], v13 offset:20480
    s_waitcnt lgkmcnt(2)
    v_mfma_f32_32x32x16_bf16 v[80:95], v[24:27], a[40:43], v[80:95]
    v_mfma_f32_32x32x16_bf16 v[96:111], v[28:31], a[40:43], v[96:111]
    s_waitcnt lgkmcnt(0)
    v_mfma_f32_32x32x16_bf16 v[80:95], v[32:35], a[44:47], v[80:95]
    v_accvgpr_write_b32 a40, v78
    v_accvgpr_write_b32 a41, v78
    v_mfma_f32_32x32x16_bf16 v[96:111], v[36:39], a[44:47], v[96:111]
    v_accvgpr_write_b32 a42, v78
    v_accvgpr_write_b32 a43, v78
    s_waitcnt vmcnt(0)
    s_mov_b32 s3, 0
    v_cmp_eq_u32 vcc, 0, v60
    s_cbranch_vccz L_Av_tok_done

L_Av_tok:
    buffer_load_dwordx2 v[60:61], v62, s[24:27], 0 offen sc1
    s_add_u32 s3, s3, 1
    s_waitcnt vmcnt(0)
    v_cmp_eq_u32 vcc, 0, v60
    s_cmp_gt_u32 s3, 20000
    s_cbranch_scc1 L_Av_tok_done
    s_cbranch_vccnz L_Av_tok

L_Av_tok_done:
    s_mov_b64 exec, 1
    buffer_store_dwordx2 v[60:61], v63, s[12:15], 0 offen sc1
    s_mov_b64 exec, -1
    v_readfirstlane_b32 s36, v60

    s_barrier
    ds_read_b128 v[16:19], v10 offset:24576
    ds_read_b128 v[20:23], v10 offset:28672
    ds_read_b128 v[24:27], v11 offset:24576
    ds_read_b128 v[28:31], v11 offset:28672
    s_waitcnt lgkmcnt(2)
    v_mfma_f32_32x32x16_bf16 v[80:95], v[16:19], a[48:51], v[80:95]
    ds_read_b128 v[32:35], v12 offset:24576
    v_accvgpr_write_b32 a44, v78
    v_accvgpr_write_b32 a45, v78
    v_mfma_f32_32x32x16_bf16 v[96:111], v[20:23], a[48:51], v[96:111]
    ds_read_b128 v[36:39], v12 offset:28672
    v_accvgpr_write_b32 a46, v78
    v_accvgpr_write_b32 a47, v78
    s_waitcnt lgkmcnt(2)
    v_mfma_f32_32x32x16_bf16 v[80:95], v[24:27], a[52:55], v[80:95]
    ds_read_b128 v[16:19], v13 offset:24576
    v_mfma_f32_32x32x16_bf16 v[96:111], v[28:31], a[52:55], v[96:111]
    ds_read_b128 v[20:23], v13 offset:28672
    s_waitcnt lgkmcnt(2)
    v_mfma_f32_32x32x16_bf16 v[80:95], v[32:35], a[56:59], v[80:95]
    ds_read_b128 v[24:27], v10 offset:32768
    v_mfma_f32_32x32x16_bf16 v[96:111], v[36:39], a[56:59], v[96:111]
    ds_read_b128 v[28:31], v10 offset:36864
    s_waitcnt lgkmcnt(2)
    v_mfma_f32_32x32x16_bf16 v[80:95], v[16:19], a[60:63], v[80:95]
    ds_read_b128 v[32:35], v11 offset:32768
    v_accvgpr_write_b32 a56, v78
    v_accvgpr_write_b32 a57, v78
    v_mfma_f32_32x32x16_bf16 v[96:111], v[20:23], a[60:63], v[96:111]
    ds_read_b128 v[36:39], v11 offset:36864
    v_accvgpr_write_b32 a58, v78
    v_accvgpr_write_b32 a59, v78
    s_waitcnt lgkmcnt(2)
    v_mfma_f32_32x32x16_bf16 v[80:95], v[24:27], a[64:67], v[80:95]
    ds_read_b128 v[16:19], v12 offset:32768
    v_accvgpr_write_b32 a60, v78
    v_accvgpr_write_b32 a61, v78
    v_mfma_f32_32x32x16_bf16 v[96:111], v[28:31], a[64:67], v[96:111]
    ds_read_b128 v[20:23], v12 offset:36864
    v_accvgpr_write_b32 a62, v78
    v_accvgpr_write_b32 a63, v78
    s_waitcnt lgkmcnt(2)
    v_mfma_f32_32x32x16_bf16 v[80:95], v[32:35], a[68:71], v[80:95]
    ds_read_b128 v[24:27], v13 offset:32768
    v_mfma_f32_32x32x16_bf16 v[96:111], v[36:39], a[68:71], v[96:111]
    ds_read_b128 v[28:31], v13 offset:36864
    s_waitcnt lgkmcnt(2)
    v_mfma_f32_32x32x16_bf16 v[80:95], v[16:19], a[72:75], v[80:95]
    ds_read_b128 v[32:35], v10 offset:40960
    v_mfma_f32_32x32x16_bf16 v[96:111], v[20:23], a[72:75], v[96:111]
    ds_read_b128 v[36:39], v10 offset:45056
    s_waitcnt lgkmcnt(2)
    v_mfma_f32_32x32x16_bf16 v[80:95], v[24:27], a[76:79], v[80:95]
    ds_read_b128 v[16:19], v11 offset:40960
    v_accvgpr_write_b32 a72, v78
    v_accvgpr_write_b32 a73, v78
    v_mfma_f32_32x32x16_bf16 v[96:111], v[28:31], a[76:79], v[96:111]
    ds_read_b128 v[20:23], v11 offset:45056
    v_accvgpr_write_b32 a74, v78
    v_accvgpr_write_b32 a75, v78
    s_waitcnt lgkmcnt(2)
    v_mfma_f32_32x32x16_bf16 v[80:95], v[32:35], a[80:83], v[80:95]
    ds_read_b128 v[24:27], v12 offset:40960
    v_accvgpr_write_b32 a76, v78
    v_accvgpr_write_b32 a77, v78
    v_mfma_f32_32x32x16_bf16 v[96:111], v[36:39], a[80:83], v[96:111]
    ds_read_b128 v[28:31], v12 offset:45056
    v_accvgpr_write_b32 a78, v78
    v_accvgpr_write_b32 a79, v78
    s_waitcnt lgkmcnt(2)
    v_mfma_f32_32x32x16_bf16 v[80:95], v[16:19], a[84:87], v[80:95]
    ds_read_b128 v[32:35], v13 offset:40960
    v_mfma_f32_32x32x16_bf16 v[96:111], v[20:23], a[84:87], v[96:111]
    ds_read_b128 v[36:39], v13 offset:45056
    s_waitcnt lgkmcnt(2)
    v_mfma_f32_32x32x16_bf16 v[80:95], v[24:27], a[88:91], v[80:95]
    ds_read_b128 v[16:19], v10 offset:49152
    v_mfma_f32_32x32x16_bf16 v[96:111], v[28:31], a[88:91], v[96:111]
    ds_read_b128 v[20:23], v10 offset:53248
    s_waitcnt lgkmcnt(2)
    v_mfma_f32_32x32x16_bf16 v[80:95], v[32:35], a[92:95], v[80:95]
    ds_read_b128 v[24:27], v11 offset:49152
    v_accvgpr_write_b32 a88, v78
    v_accvgpr_write_b32 a89, v78
    v_mfma_f32_32x32x16_bf16 v[96:111], v[36:39], a[92:95], v[96:111]
    ds_read_b128 v[28:31], v11 offset:53248
    v_accvgpr_write_b32 a90, v78
    v_accvgpr_write_b32 a91, v78
    s_waitcnt lgkmcnt(2)
    v_mfma_f32_32x32x16_bf16 v[80:95], v[16:19], a[96:99], v[80:95]
    ds_read_b128 v[32:35], v12 offset:49152
    v_accvgpr_write_b32 a92, v78
    v_accvgpr_write_b32 a93, v78
    v_mfma_f32_32x32x16_bf16 v[96:111], v[20:23], a[96:99], v[96:111]
    ds_read_b128 v[36:39], v12 offset:53248
    v_accvgpr_write_b32 a94, v78
    v_accvgpr_write_b32 a95, v78
    s_waitcnt lgkmcnt(2)
    v_mfma_f32_32x32x16_bf16 v[80:95], v[24:27], a[100:103], v[80:95]
    ds_read_b128 v[16:19], v13 offset:49152
    v_mfma_f32_32x32x16_bf16 v[96:111], v[28:31], a[100:103], v[96:111]
    ds_read_b128 v[20:23], v13 offset:53248
    s_waitcnt lgkmcnt(2)
    v_mfma_f32_32x32x16_bf16 v[80:95], v[32:35], a[104:107], v[80:95]
    v_mfma_f32_32x32x16_bf16 v[96:111], v[36:39], a[104:107], v[96:111]
    s_waitcnt lgkmcnt(0)
    v_mfma_f32_32x32x16_bf16 v[80:95], v[16:19], a[108:111], v[80:95]
    v_accvgpr_write_b32 a104, v78
    v_accvgpr_write_b32 a105, v78
    v_mfma_f32_32x32x16_bf16 v[96:111], v[20:23], a[108:111], v[96:111]
    v_accvgpr_write_b32 a106, v78
    v_accvgpr_write_b32 a107, v78
    v_accvgpr_write_b32 a108, v78
    v_accvgpr_write_b32 a109, v78
    v_accvgpr_write_b32 a110, v78
    v_accvgpr_write_b32 a111, v78
    v_accvgpr_write_b32 a120, v78
    v_accvgpr_write_b32 a121, v78
    v_accvgpr_write_b32 a122, v78
    v_accvgpr_write_b32 a123, v78
    v_accvgpr_write_b32 a124, v78
    v_accvgpr_write_b32 a125, v78
    v_accvgpr_write_b32 a126, v78
    v_accvgpr_write_b32 a127, v78
    v_cvt_pk_bf16_f32 v40, v80, v81
    v_cvt_pk_bf16_f32 v41, v82, v83
    v_cvt_pk_bf16_f32 v42, v84, v85
    v_cvt_pk_bf16_f32 v43, v86, v87
    buffer_store_dwordx4 v[40:43], v64, s[12:15], s50 offen offset:0 sc1
    v_cvt_pk_bf16_f32 v44, v88, v89
    v_cvt_pk_bf16_f32 v45, v90, v91
    v_cvt_pk_bf16_f32 v46, v92, v93
    v_cvt_pk_bf16_f32 v47, v94, v95
    buffer_store_dwordx4 v[44:47], v64, s[12:15], s50 offen offset:1024 sc1
    v_cvt_pk_bf16_f32 v48, v96, v97
    v_cvt_pk_bf16_f32 v49, v98, v99
    v_cvt_pk_bf16_f32 v50, v100, v101
    v_cvt_pk_bf16_f32 v51, v102, v103
    buffer_store_dwordx4 v[48:51], v64, s[12:15], s53 offen offset:0 sc1
    v_cvt_pk_bf16_f32 v52, v104, v105
    v_cvt_pk_bf16_f32 v53, v106, v107
    v_cvt_pk_bf16_f32 v54, v108, v109
    v_cvt_pk_bf16_f32 v55, v110, v111
    buffer_store_dwordx4 v[52:55], v64, s[12:15], s53 offen offset:1024 sc1
    s_branch L_A_cdone
L_A_idle:
    v_mov_b32 v63, 1073741824
    buffer_load_dwordx2 v[60:61], v62, s[24:27], 0 offen sc1
    s_lshl_b32 s42, s31, 18
    s_add_u32 s42, s42, 2097152
    s_lshl_b32 s44, s28, 14
    s_add_u32 s44, s44, s42

    s_add_u32 s45, s30, 0
    s_and_b32 s45, s45, 3
    s_add_u32 s46, s30, 1
    s_and_b32 s46, s46, 3
    s_add_u32 s47, s30, 3
    s_and_b32 s47, s47, 3
    s_add_u32 s48, s30, 2
    s_and_b32 s48, s48, 3
    s_and_b32 s66, s31, 3
    s_mul_i32 s66, s66, 224
    s_lshl_b32 s51, s28, 10
    s_add_u32 s51, s51, 61440
    s_cmp_eq_u32 s28, 7
    s_cselect_b32 s52, 28672, 0
    s_add_u32 s52, s52, s66

    s_add_u32 s56, s32, 0
    s_and_b32 s56, s56, 3
    s_lshl_b32 s56, s56, 12
    s_add_u32 s56, s56, s44
    s_add_u32 s60, s56, 131072
    s_add_u32 s57, s32, 1
    s_and_b32 s57, s57, 3
    s_lshl_b32 s57, s57, 12
    s_add_u32 s57, s57, s44
    s_add_u32 s61, s57, 131072
    s_add_u32 s58, s32, 2
    s_and_b32 s58, s58, 3
    s_lshl_b32 s58, s58, 12
    s_add_u32 s58, s58, s44
    s_add_u32 s62, s58, 131072
    s_add_u32 s59, s32, 3
    s_and_b32 s59, s59, 3
    s_lshl_b32 s59, s59, 12
    s_add_u32 s59, s59, s44
    s_add_u32 s63, s59, 131072
L_A_qdone:
    v_and_b32 v78, 31, v1
    v_cmp_eq_u32 vcc, 28, v78
    v_mov_b32 v78, 0
    v_mov_b32 v79, 0x3f803f80
    v_cndmask_b32 v78, v78, v79, vcc

    v_accvgpr_write_b32 a8, v78
    v_accvgpr_write_b32 a9, v78
    v_accvgpr_write_b32 a10, v78
    v_accvgpr_write_b32 a11, v78
    v_accvgpr_write_b32 a12, v78
    v_accvgpr_write_b32 a13, v78
    v_accvgpr_write_b32 a14, v78
    v_accvgpr_write_b32 a15, v78
    v_accvgpr_write_b32 a24, v78
    v_accvgpr_write_b32 a25, v78
    v_accvgpr_write_b32 a26, v78
    v_accvgpr_write_b32 a27, v78
    v_accvgpr_write_b32 a28, v78
    v_accvgpr_write_b32 a29, v78
    v_accvgpr_write_b32 a30, v78
    v_accvgpr_write_b32 a31, v78
    v_accvgpr_write_b32 a40, v78
    v_accvgpr_write_b32 a41, v78
    v_accvgpr_write_b32 a42, v78
    v_accvgpr_write_b32 a43, v78
    v_accvgpr_write_b32 a44, v78
    v_accvgpr_write_b32 a45, v78
    v_accvgpr_write_b32 a46, v78
    v_accvgpr_write_b32 a47, v78
    v_accvgpr_write_b32 a56, v78
    v_accvgpr_write_b32 a57, v78
    v_accvgpr_write_b32 a58, v78
    v_accvgpr_write_b32 a59, v78
    v_accvgpr_write_b32 a60, v78
    v_accvgpr_write_b32 a61, v78
    v_accvgpr_write_b32 a62, v78
    v_accvgpr_write_b32 a63, v78
    v_accvgpr_write_b32 a72, v78
    v_accvgpr_write_b32 a73, v78
    v_accvgpr_write_b32 a74, v78
    v_accvgpr_write_b32 a75, v78
    v_accvgpr_write_b32 a76, v78
    v_accvgpr_write_b32 a77, v78
    v_accvgpr_write_b32 a78, v78
    v_accvgpr_write_b32 a79, v78
    v_accvgpr_write_b32 a88, v78
    v_accvgpr_write_b32 a89, v78
    v_accvgpr_write_b32 a90, v78
    v_accvgpr_write_b32 a91, v78
    v_accvgpr_write_b32 a92, v78
    v_accvgpr_write_b32 a93, v78
    v_accvgpr_write_b32 a94, v78
    v_accvgpr_write_b32 a95, v78
    v_accvgpr_write_b32 a104, v78
    v_accvgpr_write_b32 a105, v78
    v_accvgpr_write_b32 a106, v78
    v_accvgpr_write_b32 a107, v78
    v_accvgpr_write_b32 a108, v78
    v_accvgpr_write_b32 a109, v78
    v_accvgpr_write_b32 a110, v78
    v_accvgpr_write_b32 a111, v78
    v_accvgpr_write_b32 a120, v78
    v_accvgpr_write_b32 a121, v78
    v_accvgpr_write_b32 a122, v78
    v_accvgpr_write_b32 a123, v78
    v_accvgpr_write_b32 a124, v78
    v_accvgpr_write_b32 a125, v78
    v_accvgpr_write_b32 a126, v78
    v_accvgpr_write_b32 a127, v78
    s_waitcnt vmcnt(0)
    s_mov_b32 s3, 0
    v_cmp_eq_u32 vcc, 0, v60
    s_cbranch_vccz L_Aq_tok_done

L_Aq_tok:
    buffer_load_dwordx2 v[60:61], v62, s[24:27], 0 offen sc1
    s_add_u32 s3, s3, 1
    s_waitcnt vmcnt(0)
    v_cmp_eq_u32 vcc, 0, v60
    s_cmp_gt_u32 s3, 20000
    s_cbranch_scc1 L_Aq_tok_done
    s_cbranch_vccnz L_Aq_tok

L_Aq_tok_done:
    s_mov_b64 exec, 1
    buffer_store_dwordx2 v[60:61], v63, s[12:15], 0 offen sc1
    s_mov_b64 exec, -1
    v_readfirstlane_b32 s36, v60

L_A_cdone:
    s_mul_i32 s49, s31, 28
    v_and_b32 v32, 1, v1
    v_mul_u32_u24 v32, 27, v32
    v_add_u32 v32, s49, v32
    v_lshrrev_b32 v32, 5, v32
    v_bfe_u32 v33, v1, 1, 1
    v_mul_u32_u24 v33, 14, v33
    v_add3_u32 v32, v32, v33, 14
    v_bfe_u32 v33, v1, 2, 1
    v_lshl_add_u32 v32, v32, 5, v33
    s_lshl_b32 s49, s28, 1
    s_add_u32 s49, s49, 16
    v_add_u32 v32, s49, v32
    v_lshlrev_b32 v32, 7, v32
    v_add_u32 v7, 8388608, v32
    s_cmp_eq_u32 s28, 7
    s_cselect_b32 s49, 0, s28
    s_lshl_b32 s49, s49, 6
    v_add_u32 v32, s49, v1
    v_mul_u32_u24 v33, 586, v32
    v_lshrrev_b32 v33, 13, v33
    v_mul_u32_u24 v34, 14, v33
    v_sub_u32 v32, v32, v34
    v_mul_u32_u24 v33, 896, v33
    v_lshl_add_u32 v5, v32, 4, v33
    v_lshlrev_b32 v1, 4, v1
    s_lshl_b32 s43, s29, 14
    s_lshl_b32 s49, s45, 12
    s_add_u32 s49, s49, s43
    v_add_u32 v2, s49, v1
    s_lshl_b32 s49, s46, 12
    s_add_u32 s49, s49, s43
    s_add_u32 s49, s49, 32768
    v_add_u32 v3, s49, v1
    s_lshl_b32 s49, s47, 12
    s_add_u32 s49, s49, s43
    v_add_u32 v4, s49, v1
    s_lshl_b32 s49, s48, 12
    s_add_u32 s49, s49, s43
    v_add_u32 v6, s49, v1

    s_lshl_b32 s49, s45, 11
    s_add_u32 s49, s49, 65536
    v_add_u32 v72, s49, v1
    s_lshl_b32 s49, s46, 11
    s_add_u32 s49, s49, 65536
    v_add_u32 v73, s49, v1
    s_lshl_b32 s49, s47, 11
    s_add_u32 s49, s49, 65536
    v_add_u32 v74, s49, v1
    s_lshl_b32 s49, s48, 11
    s_add_u32 s49, s49, 65536
    v_add_u32 v75, s49, v1
    s_waitcnt vmcnt(0)
    s_mov_b64 exec, 1
    buffer_store_dword v60, v1, s[12:15], s37 offen sc1
    s_mov_b64 exec, -1

L_B1:
    s_barrier
    buffer_load_dwordx4 a[0:3], v1, s[12:15], s56 offen offset:0 sc1
    buffer_load_dwordx4 a[4:7], v1, s[12:15], s56 offen offset:1024 sc1
    s_mov_b64 exec, s[40:41]
    buffer_load_dwordx4 a[8:11], v1, s[12:15], s56 offen offset:2048 sc1
    buffer_load_dwordx4 a[12:15], v1, s[12:15], s56 offen offset:3072 sc1
    s_mov_b64 exec, -1
    s_cmp_eq_u32 s29, 0
    s_cbranch_scc1 L_B2
    s_waitcnt vmcnt(4)
    s_mov_b64 exec, s[38:39]
    v_mov_b32 v22, 0
    v_mov_b32 v23, 0
    s_mov_b64 exec, -1
    s_nop 0
    v_mfma_f32_32x32x16_bf16 v[40:55], v[104:107], v[16:19], 0
    v_mfma_f32_32x32x16_bf16 v[40:55], v[108:111], v[20:23], v[40:55]
    ds_write_b128 v72, v[16:19]
    s_nop 11
    v_cvt_pk_bf16_f32 v41, -v40, -v40
    v_lshlrev_b32 v41, 16, v41
    v_sub_f32 v41, -v40, v41
    s_mov_b64 exec, s[38:39]
    v_cvt_pk_bf16_f32 v22, -v40, v41
    s_mov_b64 exec, -1
    ds_write_b128 v72, v[20:23] offset:1024
    s_waitcnt lgkmcnt(0)
    s_barrier

    ds_read_b128 v[8:11], v72
    ds_read_b128 v[12:15], v72 offset:1024
    ds_read_b128 v[16:19], v73
    ds_read_b128 v[20:23], v73 offset:1024
    ds_read_b128 v[24:27], v74
    ds_read_b128 v[28:31], v74 offset:1024
    ds_read_b128 v[32:35], v75
    ds_read_b128 v[36:39], v75 offset:1024
    buffer_load_dwordx4 a[16:19], v1, s[12:15], s57 offen offset:0 sc1
    buffer_load_dwordx4 a[20:23], v1, s[12:15], s57 offen offset:1024 sc1
    s_mov_b64 exec, s[40:41]
    buffer_load_dwordx4 a[24:27], v1, s[12:15], s57 offen offset:2048 sc1
    buffer_load_dwordx4 a[28:31], v1, s[12:15], s57 offen offset:3072 sc1
    s_mov_b64 exec, -1
    s_branch L_B3
L_B2:
    buffer_load_dwordx4 a[16:19], v1, s[12:15], s57 offen offset:0 sc1
    buffer_load_dwordx4 a[20:23], v1, s[12:15], s57 offen offset:1024 sc1
    s_mov_b64 exec, s[40:41]
    buffer_load_dwordx4 a[24:27], v1, s[12:15], s57 offen offset:2048 sc1
    buffer_load_dwordx4 a[28:31], v1, s[12:15], s57 offen offset:3072 sc1
    s_mov_b64 exec, -1
    s_barrier
    ds_read_b128 v[8:11], v72
    ds_read_b128 v[12:15], v72 offset:1024
    ds_read_b128 v[16:19], v73
    ds_read_b128 v[20:23], v73 offset:1024
    ds_read_b128 v[24:27], v74
    ds_read_b128 v[28:31], v74 offset:1024
    ds_read_b128 v[32:35], v75
    ds_read_b128 v[36:39], v75 offset:1024
L_B3:
    s_waitcnt lgkmcnt(0)
    s_waitcnt vmcnt(6)
    v_mfma_f32_32x32x16_bf16 v[40:55], a[0:3], v[8:11], 0
    buffer_load_dwordx4 a[32:35], v1, s[12:15], s58 offen offset:0 sc1
    s_setprio 3
    buffer_load_dwordx4 a[36:39], v1, s[12:15], s58 offen offset:1024 sc1
    s_mov_b64 exec, s[40:41]
    buffer_load_dwordx4 a[40:43], v1, s[12:15], s58 offen offset:2048 sc1
    buffer_load_dwordx4 a[44:47], v1, s[12:15], s58 offen offset:3072 sc1
    s_mov_b64 exec, -1
    v_mfma_f32_32x32x16_bf16 v[40:55], a[4:7], v[12:15], v[40:55]
    buffer_load_dwordx4 a[48:51], v1, s[12:15], s59 offen offset:0 sc1
    buffer_load_dwordx4 a[52:55], v1, s[12:15], s59 offen offset:1024 sc1
    s_mov_b64 exec, s[40:41]
    buffer_load_dwordx4 a[56:59], v1, s[12:15], s59 offen offset:2048 sc1
    buffer_load_dwordx4 a[60:63], v1, s[12:15], s59 offen offset:3072 sc1
    s_mov_b64 exec, -1
    s_nop 0
    s_nop 0
    s_nop 0
    v_mfma_f32_32x32x16_bf16 v[56:71], a[0:3], v[16:19], 0
    s_nop 0
    s_nop 0
    s_nop 0
    v_exp_f32 v40, v40
    v_exp_f32 v41, v41
    v_exp_f32 v42, v42
    v_mfma_f32_32x32x16_bf16 v[56:71], a[4:7], v[20:23], v[56:71]
    v_exp_f32 v43, v43
    v_cvt_pk_bf16_f32 v104, v40, v41
    v_cvt_pk_bf16_f32 v105, v42, v43
    v_exp_f32 v44, v44
    v_exp_f32 v45, v45
    v_exp_f32 v46, v46
    v_exp_f32 v47, v47
    v_cvt_pk_bf16_f32 v106, v44, v45
    v_cvt_pk_bf16_f32 v107, v46, v47
    v_exp_f32 v48, v48
    v_exp_f32 v49, v49
    s_waitcnt vmcnt(12)
    v_mfma_f32_32x32x16_bf16 v[72:87], a[8:11], v[104:107], 0
    v_exp_f32 v50, v50
    v_exp_f32 v51, v51
    v_cvt_pk_bf16_f32 v108, v48, v49
    v_cvt_pk_bf16_f32 v109, v50, v51
    v_exp_f32 v52, v52
    v_exp_f32 v53, v53
    v_exp_f32 v54, v54
    v_exp_f32 v55, v55
    v_cvt_pk_bf16_f32 v110, v52, v53
    v_cvt_pk_bf16_f32 v111, v54, v55
    s_waitcnt vmcnt(10)
    v_mfma_f32_32x32x16_bf16 v[40:55], a[16:19], v[8:11], 0
    v_exp_f32 v56, v56
    v_exp_f32 v57, v57
    v_exp_f32 v58, v58
    v_exp_f32 v59, v59
    v_cvt_pk_bf16_f32 v112, v56, v57
    v_mfma_f32_32x32x16_bf16 v[40:55], a[20:23], v[12:15], v[40:55]
    v_cvt_pk_bf16_f32 v113, v58, v59
    v_exp_f32 v60, v60
    v_exp_f32 v61, v61
    v_exp_f32 v62, v62
    v_exp_f32 v63, v63
    v_mfma_f32_32x32x16_bf16 v[72:87], a[12:15], v[108:111], v[72:87]
    v_cvt_pk_bf16_f32 v114, v60, v61
    v_cvt_pk_bf16_f32 v115, v62, v63
    v_exp_f32 v64, v64
    v_exp_f32 v65, v65
    v_exp_f32 v66, v66
    v_exp_f32 v67, v67
    v_mfma_f32_32x32x16_bf16 v[88:103], a[8:11], v[112:115], 0
    v_cvt_pk_bf16_f32 v116, v64, v65
    v_cvt_pk_bf16_f32 v117, v66, v67
    v_exp_f32 v68, v68
    v_exp_f32 v69, v69
    v_exp_f32 v70, v70
    v_exp_f32 v71, v71
    v_cvt_pk_bf16_f32 v118, v68, v69
    v_cvt_pk_bf16_f32 v119, v70, v71
    v_mfma_f32_32x32x16_bf16 v[56:71], a[16:19], v[16:19], 0
    v_exp_f32 v40, v40
    s_mov_b64 exec, 0xff
    buffer_load_dword a64, v7, s[12:15], 0 offen sc1
    s_mov_b64 exec, -1
    v_exp_f32 v41, v41
    v_exp_f32 v42, v42
    v_mfma_f32_32x32x16_bf16 v[56:71], a[20:23], v[20:23], v[56:71]
    v_exp_f32 v43, v43
    v_cvt_pk_bf16_f32 v120, v40, v41
    v_cvt_pk_bf16_f32 v121, v42, v43
    v_exp_f32 v44, v44
    v_exp_f32 v45, v45
    v_exp_f32 v46, v46
    v_mfma_f32_32x32x16_bf16 v[88:103], a[12:15], v[116:119], v[88:103]
    v_exp_f32 v47, v47
    v_cvt_pk_bf16_f32 v122, v44, v45
    v_cvt_pk_bf16_f32 v123, v46, v47
    v_exp_f32 v48, v48
    v_exp_f32 v49, v49
    v_exp_f32 v50, v50
    s_waitcnt vmcnt(9)
    v_mfma_f32_32x32x16_bf16 v[72:87], a[24:27], v[120:123], v[72:87]
    v_exp_f32 v51, v51
    v_cvt_pk_bf16_f32 v124, v48, v49
    v_cvt_pk_bf16_f32 v125, v50, v51
    v_exp_f32 v52, v52
    v_exp_f32 v53, v53
    v_exp_f32 v54, v54
    v_exp_f32 v55, v55
    v_cvt_pk_bf16_f32 v126, v52, v53
    v_cvt_pk_bf16_f32 v127, v54, v55
    s_waitcnt vmcnt(7)
    v_mfma_f32_32x32x16_bf16 v[40:55], a[32:35], v[8:11], 0
    v_exp_f32 v56, v56
    v_exp_f32 v57, v57
    v_exp_f32 v58, v58
    v_exp_f32 v59, v59
    v_cvt_pk_bf16_f32 v104, v56, v57
    v_mfma_f32_32x32x16_bf16 v[40:55], a[36:39], v[12:15], v[40:55]
    v_cvt_pk_bf16_f32 v105, v58, v59
    v_exp_f32 v60, v60
    v_exp_f32 v61, v61
    v_exp_f32 v62, v62
    v_exp_f32 v63, v63
    v_mfma_f32_32x32x16_bf16 v[72:87], a[28:31], v[124:127], v[72:87]
    v_cvt_pk_bf16_f32 v106, v60, v61
    v_cvt_pk_bf16_f32 v107, v62, v63
    v_exp_f32 v64, v64
    v_exp_f32 v65, v65
    v_exp_f32 v66, v66
    v_exp_f32 v67, v67
    v_mfma_f32_32x32x16_bf16 v[88:103], a[24:27], v[104:107], v[88:103]
    v_cvt_pk_bf16_f32 v108, v64, v65
    v_cvt_pk_bf16_f32 v109, v66, v67
    v_exp_f32 v68, v68
    v_exp_f32 v69, v69
    v_exp_f32 v70, v70
    v_exp_f32 v71, v71
    v_cvt_pk_bf16_f32 v110, v68, v69
    v_cvt_pk_bf16_f32 v111, v70, v71
    v_mfma_f32_32x32x16_bf16 v[56:71], a[32:35], v[16:19], 0
    v_exp_f32 v40, v40
    s_waitcnt vmcnt(0)
    s_mov_b64 exec, 0xff
    v_accvgpr_write_b32 a65, v7
    v_accvgpr_read_b32 v7, a64
    s_mov_b32 s49, 0
    v_cmp_ne_u32 vcc, s36, v7
    s_cbranch_vccz L_late_ok

L_late:
    v_accvgpr_read_b32 v7, a65
    s_add_u32 s49, s49, 1
    buffer_load_dword v7, v7, s[12:15], 0 offen sc1
    s_waitcnt vmcnt(0)
    v_cmp_ne_u32 vcc, s36, v7
    s_cmp_gt_u32 s49, 20000
    s_cbranch_scc1 L_late_ok
    s_cbranch_vccnz L_late

L_late_ok:
    s_mov_b64 exec, -1
    v_exp_f32 v41, v41
    v_mfma_f32_32x32x16_bf16 v[56:71], a[36:39], v[20:23], v[56:71]
    buffer_load_dwordx4 a[64:67], v1, s[12:15], s60 offen offset:0 sc1
    v_exp_f32 v42, v42
    buffer_load_dwordx4 a[68:71], v1, s[12:15], s60 offen offset:1024 sc1
    v_exp_f32 v43, v43
    s_mov_b64 exec, s[40:41]
    buffer_load_dwordx4 a[72:75], v1, s[12:15], s60 offen offset:2048 sc1
    buffer_load_dwordx4 a[76:79], v1, s[12:15], s60 offen offset:3072 sc1
    s_mov_b64 exec, -1
    v_cvt_pk_bf16_f32 v112, v40, v41
    v_mfma_f32_32x32x16_bf16 v[88:103], a[28:31], v[108:111], v[88:103]
    buffer_load_dwordx4 a[80:83], v1, s[12:15], s61 offen offset:0 sc1
    v_cvt_pk_bf16_f32 v113, v42, v43
    buffer_load_dwordx4 a[84:87], v1, s[12:15], s61 offen offset:1024 sc1
    v_exp_f32 v44, v44
    s_mov_b64 exec, s[40:41]
    buffer_load_dwordx4 a[88:91], v1, s[12:15], s61 offen offset:2048 sc1
    buffer_load_dwordx4 a[92:95], v1, s[12:15], s61 offen offset:3072 sc1
    s_mov_b64 exec, -1
    v_exp_f32 v45, v45
    v_exp_f32 v46, v46
    v_exp_f32 v47, v47
    v_cvt_pk_bf16_f32 v114, v44, v45
    v_cvt_pk_bf16_f32 v115, v46, v47
    v_exp_f32 v48, v48
    v_exp_f32 v49, v49
    s_waitcnt vmcnt(13)
    v_mfma_f32_32x32x16_bf16 v[72:87], a[40:43], v[112:115], v[72:87]
    v_exp_f32 v50, v50
    v_exp_f32 v51, v51
    v_cvt_pk_bf16_f32 v116, v48, v49
    v_cvt_pk_bf16_f32 v117, v50, v51
    v_exp_f32 v52, v52
    v_exp_f32 v53, v53
    v_exp_f32 v54, v54
    v_exp_f32 v55, v55
    v_cvt_pk_bf16_f32 v118, v52, v53
    v_cvt_pk_bf16_f32 v119, v54, v55
    s_waitcnt vmcnt(11)
    v_mfma_f32_32x32x16_bf16 v[40:55], a[48:51], v[8:11], 0
    buffer_load_dwordx4 a[96:99], v1, s[12:15], s62 offen offset:0 sc1
    v_exp_f32 v56, v56
    buffer_load_dwordx4 a[100:103], v1, s[12:15], s62 offen offset:1024 sc1
    v_exp_f32 v57, v57
    s_mov_b64 exec, s[40:41]
    buffer_load_dwordx4 a[104:107], v1, s[12:15], s62 offen offset:2048 sc1
    buffer_load_dwordx4 a[108:111], v1, s[12:15], s62 offen offset:3072 sc1
    s_mov_b64 exec, -1
    v_exp_f32 v58, v58
    v_mfma_f32_32x32x16_bf16 v[40:55], a[52:55], v[12:15], v[40:55]
    v_exp_f32 v59, v59
    v_cvt_pk_bf16_f32 v120, v56, v57
    v_cvt_pk_bf16_f32 v121, v58, v59
    v_exp_f32 v60, v60
    v_exp_f32 v61, v61
    v_exp_f32 v62, v62
    v_mfma_f32_32x32x16_bf16 v[72:87], a[44:47], v[116:119], v[72:87]
    v_exp_f32 v63, v63
    v_cvt_pk_bf16_f32 v122, v60, v61
    v_cvt_pk_bf16_f32 v123, v62, v63
    v_exp_f32 v64, v64
    v_exp_f32 v65, v65
    v_exp_f32 v66, v66
    v_mfma_f32_32x32x16_bf16 v[88:103], a[40:43], v[120:123], v[88:103]
    v_exp_f32 v67, v67
    v_cvt_pk_bf16_f32 v124, v64, v65
    v_cvt_pk_bf16_f32 v125, v66, v67
    v_exp_f32 v68, v68
    v_exp_f32 v69, v69
    v_exp_f32 v70, v70
    v_exp_f32 v71, v71
    v_cvt_pk_bf16_f32 v126, v68, v69
    v_cvt_pk_bf16_f32 v127, v70, v71
    v_mfma_f32_32x32x16_bf16 v[56:71], a[48:51], v[16:19], 0
    v_exp_f32 v40, v40
    v_exp_f32 v41, v41
    v_exp_f32 v42, v42
    v_exp_f32 v43, v43
    v_cvt_pk_bf16_f32 v104, v40, v41
    v_mfma_f32_32x32x16_bf16 v[56:71], a[52:55], v[20:23], v[56:71]
    v_cvt_pk_bf16_f32 v105, v42, v43
    v_exp_f32 v44, v44
    v_exp_f32 v45, v45
    v_exp_f32 v46, v46
    v_exp_f32 v47, v47
    v_mfma_f32_32x32x16_bf16 v[88:103], a[44:47], v[124:127], v[88:103]
    v_cvt_pk_bf16_f32 v106, v44, v45
    v_cvt_pk_bf16_f32 v107, v46, v47
    v_exp_f32 v48, v48
    v_exp_f32 v49, v49
    v_exp_f32 v50, v50
    v_exp_f32 v51, v51
    s_waitcnt vmcnt(13)
    v_mfma_f32_32x32x16_bf16 v[72:87], a[56:59], v[104:107], v[72:87]
    v_cvt_pk_bf16_f32 v108, v48, v49
    v_cvt_pk_bf16_f32 v109, v50, v51
    v_exp_f32 v52, v52
    v_exp_f32 v53, v53
    v_exp_f32 v54, v54
    v_exp_f32 v55, v55
    v_cvt_pk_bf16_f32 v110, v52, v53
    v_cvt_pk_bf16_f32 v111, v54, v55
    s_waitcnt vmcnt(10)
    v_mfma_f32_32x32x16_bf16 v[40:55], a[64:67], v[8:11], 0
    buffer_load_dwordx4 a[112:115], v1, s[12:15], s63 offen offset:0 sc1
    v_exp_f32 v56, v56
    buffer_load_dwordx4 a[116:119], v1, s[12:15], s63 offen offset:1024 sc1
    v_exp_f32 v57, v57
    s_mov_b64 exec, s[40:41]
    buffer_load_dwordx4 a[120:123], v1, s[12:15], s63 offen offset:2048 sc1
    buffer_load_dwordx4 a[124:127], v1, s[12:15], s63 offen offset:3072 sc1
    s_mov_b64 exec, -1
    v_exp_f32 v58, v58
    v_mfma_f32_32x32x16_bf16 v[40:55], a[68:71], v[12:15], v[40:55]
    v_exp_f32 v59, v59
    v_cvt_pk_bf16_f32 v112, v56, v57
    v_cvt_pk_bf16_f32 v113, v58, v59
    v_exp_f32 v60, v60
    v_exp_f32 v61, v61
    v_exp_f32 v62, v62
    v_mfma_f32_32x32x16_bf16 v[72:87], a[60:63], v[108:111], v[72:87]
    v_exp_f32 v63, v63
    v_cvt_pk_bf16_f32 v114, v60, v61
    v_cvt_pk_bf16_f32 v115, v62, v63
    v_exp_f32 v64, v64
    v_exp_f32 v65, v65
    v_exp_f32 v66, v66
    v_mfma_f32_32x32x16_bf16 v[88:103], a[56:59], v[112:115], v[88:103]
    v_exp_f32 v67, v67
    v_cvt_pk_bf16_f32 v116, v64, v65
    v_cvt_pk_bf16_f32 v117, v66, v67
    v_exp_f32 v68, v68
    v_exp_f32 v69, v69
    v_exp_f32 v70, v70
    v_exp_f32 v71, v71
    v_cvt_pk_bf16_f32 v118, v68, v69
    v_cvt_pk_bf16_f32 v119, v70, v71
    v_mfma_f32_32x32x16_bf16 v[56:71], a[64:67], v[16:19], 0
    v_exp_f32 v40, v40
    v_exp_f32 v41, v41
    v_exp_f32 v42, v42
    v_exp_f32 v43, v43
    v_cvt_pk_bf16_f32 v120, v40, v41
    v_mfma_f32_32x32x16_bf16 v[56:71], a[68:71], v[20:23], v[56:71]
    v_cvt_pk_bf16_f32 v121, v42, v43
    v_exp_f32 v44, v44
    v_exp_f32 v45, v45
    v_exp_f32 v46, v46
    v_exp_f32 v47, v47
    v_mfma_f32_32x32x16_bf16 v[88:103], a[60:63], v[116:119], v[88:103]
    v_cvt_pk_bf16_f32 v122, v44, v45
    v_cvt_pk_bf16_f32 v123, v46, v47
    v_exp_f32 v48, v48
    v_exp_f32 v49, v49
    v_exp_f32 v50, v50
    v_exp_f32 v51, v51
    s_waitcnt vmcnt(12)
    v_mfma_f32_32x32x16_bf16 v[72:87], a[72:75], v[120:123], v[72:87]
    v_cvt_pk_bf16_f32 v124, v48, v49
    v_cvt_pk_bf16_f32 v125, v50, v51
    v_exp_f32 v52, v52
    v_exp_f32 v53, v53
    v_exp_f32 v54, v54
    v_exp_f32 v55, v55
    s_setprio 2
    v_cvt_pk_bf16_f32 v126, v52, v53
    v_cvt_pk_bf16_f32 v127, v54, v55
    s_waitcnt vmcnt(10)
    v_mfma_f32_32x32x16_bf16 v[40:55], a[80:83], v[8:11], 0
    v_exp_f32 v56, v56
    v_exp_f32 v57, v57
    v_exp_f32 v58, v58
    v_exp_f32 v59, v59
    v_cvt_pk_bf16_f32 v104, v56, v57
    v_mfma_f32_32x32x16_bf16 v[40:55], a[84:87], v[12:15], v[40:55]
    v_cvt_pk_bf16_f32 v105, v58, v59
    v_exp_f32 v60, v60
    v_exp_f32 v61, v61
    v_exp_f32 v62, v62
    v_exp_f32 v63, v63
    v_mfma_f32_32x32x16_bf16 v[72:87], a[76:79], v[124:127], v[72:87]
    v_cvt_pk_bf16_f32 v106, v60, v61
    v_cvt_pk_bf16_f32 v107, v62, v63
    v_exp_f32 v64, v64
    v_exp_f32 v65, v65
    v_exp_f32 v66, v66
    v_exp_f32 v67, v67
    v_mfma_f32_32x32x16_bf16 v[88:103], a[72:75], v[104:107], v[88:103]
    v_cvt_pk_bf16_f32 v108, v64, v65
    v_cvt_pk_bf16_f32 v109, v66, v67
    v_exp_f32 v68, v68
    v_exp_f32 v69, v69
    v_exp_f32 v70, v70
    v_exp_f32 v71, v71
    v_cvt_pk_bf16_f32 v110, v68, v69
    v_cvt_pk_bf16_f32 v111, v70, v71
    v_mfma_f32_32x32x16_bf16 v[56:71], a[80:83], v[16:19], 0
    v_exp_f32 v40, v40
    v_exp_f32 v41, v41
    v_exp_f32 v42, v42
    v_exp_f32 v43, v43
    v_cvt_pk_bf16_f32 v112, v40, v41
    v_mfma_f32_32x32x16_bf16 v[56:71], a[84:87], v[20:23], v[56:71]
    v_cvt_pk_bf16_f32 v113, v42, v43
    v_exp_f32 v44, v44
    v_exp_f32 v45, v45
    v_exp_f32 v46, v46
    v_exp_f32 v47, v47
    v_mfma_f32_32x32x16_bf16 v[88:103], a[76:79], v[108:111], v[88:103]
    v_cvt_pk_bf16_f32 v114, v44, v45
    v_cvt_pk_bf16_f32 v115, v46, v47
    v_exp_f32 v48, v48
    v_exp_f32 v49, v49
    v_exp_f32 v50, v50
    v_exp_f32 v51, v51
    s_waitcnt vmcnt(8)
    v_mfma_f32_32x32x16_bf16 v[72:87], a[88:91], v[112:115], v[72:87]
    v_cvt_pk_bf16_f32 v116, v48, v49
    v_cvt_pk_bf16_f32 v117, v50, v51
    v_exp_f32 v52, v52
    v_exp_f32 v53, v53
    v_exp_f32 v54, v54
    v_exp_f32 v55, v55
    v_cvt_pk_bf16_f32 v118, v52, v53
    v_cvt_pk_bf16_f32 v119, v54, v55
    s_waitcnt vmcnt(6)
    v_mfma_f32_32x32x16_bf16 v[40:55], a[96:99], v[8:11], 0
    v_exp_f32 v56, v56
    v_exp_f32 v57, v57
    v_exp_f32 v58, v58
    v_exp_f32 v59, v59
    v_cvt_pk_bf16_f32 v120, v56, v57
    v_mfma_f32_32x32x16_bf16 v[40:55], a[100:103], v[12:15], v[40:55]
    v_cvt_pk_bf16_f32 v121, v58, v59
    v_exp_f32 v60, v60
    v_exp_f32 v61, v61
    v_exp_f32 v62, v62
    v_exp_f32 v63, v63
    v_mfma_f32_32x32x16_bf16 v[72:87], a[92:95], v[116:119], v[72:87]
    v_cvt_pk_bf16_f32 v122, v60, v61
    v_cvt_pk_bf16_f32 v123, v62, v63
    v_exp_f32 v64, v64
    v_exp_f32 v65, v65
    v_exp_f32 v66, v66
    v_exp_f32 v67, v67
    v_mfma_f32_32x32x16_bf16 v[88:103], a[88:91], v[120:123], v[88:103]
    v_cvt_pk_bf16_f32 v124, v64, v65
    v_cvt_pk_bf16_f32 v125, v66, v67
    v_exp_f32 v68, v68
    v_exp_f32 v69, v69
    v_exp_f32 v70, v70
    v_exp_f32 v71, v71
    v_cvt_pk_bf16_f32 v126, v68, v69
    v_cvt_pk_bf16_f32 v127, v70, v71
    v_mfma_f32_32x32x16_bf16 v[56:71], a[96:99], v[16:19], 0
    v_exp_f32 v40, v40
    v_exp_f32 v41, v41
    v_exp_f32 v42, v42
    v_exp_f32 v43, v43
    v_cvt_pk_bf16_f32 v104, v40, v41
    v_mfma_f32_32x32x16_bf16 v[56:71], a[100:103], v[20:23], v[56:71]
    v_cvt_pk_bf16_f32 v105, v42, v43
    v_exp_f32 v44, v44
    v_exp_f32 v45, v45
    v_exp_f32 v46, v46
    v_exp_f32 v47, v47
    v_mfma_f32_32x32x16_bf16 v[88:103], a[92:95], v[124:127], v[88:103]
    v_cvt_pk_bf16_f32 v106, v44, v45
    v_cvt_pk_bf16_f32 v107, v46, v47
    v_exp_f32 v48, v48
    v_exp_f32 v49, v49
    v_exp_f32 v50, v50
    v_exp_f32 v51, v51
    s_waitcnt vmcnt(4)
    v_mfma_f32_32x32x16_bf16 v[72:87], a[104:107], v[104:107], v[72:87]
    v_cvt_pk_bf16_f32 v108, v48, v49
    v_cvt_pk_bf16_f32 v109, v50, v51
    v_exp_f32 v52, v52
    v_exp_f32 v53, v53
    v_exp_f32 v54, v54
    v_exp_f32 v55, v55
    v_cvt_pk_bf16_f32 v110, v52, v53
    v_cvt_pk_bf16_f32 v111, v54, v55
    s_waitcnt vmcnt(2)
    v_mfma_f32_32x32x16_bf16 v[40:55], a[112:115], v[8:11], 0
    v_exp_f32 v56, v56
    v_exp_f32 v57, v57
    v_exp_f32 v58, v58
    v_exp_f32 v59, v59
    v_cvt_pk_bf16_f32 v112, v56, v57
    v_mfma_f32_32x32x16_bf16 v[40:55], a[116:119], v[12:15], v[40:55]
    v_cvt_pk_bf16_f32 v113, v58, v59
    v_exp_f32 v60, v60
    v_exp_f32 v61, v61
    v_exp_f32 v62, v62
    v_exp_f32 v63, v63
    v_mfma_f32_32x32x16_bf16 v[72:87], a[108:111], v[108:111], v[72:87]
    v_cvt_pk_bf16_f32 v114, v60, v61
    v_cvt_pk_bf16_f32 v115, v62, v63
    v_exp_f32 v64, v64
    v_exp_f32 v65, v65
    v_exp_f32 v66, v66
    v_exp_f32 v67, v67
    v_mfma_f32_32x32x16_bf16 v[88:103], a[104:107], v[112:115], v[88:103]
    v_cvt_pk_bf16_f32 v116, v64, v65
    v_cvt_pk_bf16_f32 v117, v66, v67
    v_exp_f32 v68, v68
    v_exp_f32 v69, v69
    v_exp_f32 v70, v70
    v_exp_f32 v71, v71
    s_setprio 1
    v_cvt_pk_bf16_f32 v118, v68, v69
    v_cvt_pk_bf16_f32 v119, v70, v71
    v_mfma_f32_32x32x16_bf16 v[56:71], a[112:115], v[16:19], 0
    v_exp_f32 v40, v40
    v_exp_f32 v41, v41
    v_exp_f32 v42, v42
    v_exp_f32 v43, v43
    v_cvt_pk_bf16_f32 v120, v40, v41
    v_mfma_f32_32x32x16_bf16 v[56:71], a[116:119], v[20:23], v[56:71]
    v_cvt_pk_bf16_f32 v121, v42, v43
    v_exp_f32 v44, v44
    v_exp_f32 v45, v45
    v_exp_f32 v46, v46
    v_exp_f32 v47, v47
    v_mfma_f32_32x32x16_bf16 v[88:103], a[108:111], v[116:119], v[88:103]
    v_cvt_pk_bf16_f32 v122, v44, v45
    v_cvt_pk_bf16_f32 v123, v46, v47
    v_exp_f32 v48, v48
    v_exp_f32 v49, v49
    v_exp_f32 v50, v50
    v_exp_f32 v51, v51
    s_waitcnt vmcnt(0)
    v_mfma_f32_32x32x16_bf16 v[72:87], a[120:123], v[120:123], v[72:87]
    v_cvt_pk_bf16_f32 v124, v48, v49
    v_cvt_pk_bf16_f32 v125, v50, v51
    v_exp_f32 v52, v52
    v_exp_f32 v53, v53
    v_exp_f32 v54, v54
    v_exp_f32 v55, v55
    v_cvt_pk_bf16_f32 v126, v52, v53
    v_cvt_pk_bf16_f32 v127, v54, v55
    v_mfma_f32_32x32x16_bf16 v[40:55], a[0:3], v[24:27], 0
    v_exp_f32 v56, v56
    v_exp_f32 v57, v57
    v_exp_f32 v58, v58
    v_exp_f32 v59, v59
    v_cvt_pk_bf16_f32 v104, v56, v57
    v_mfma_f32_32x32x16_bf16 v[40:55], a[4:7], v[28:31], v[40:55]
    v_cvt_pk_bf16_f32 v105, v58, v59
    v_exp_f32 v60, v60
    v_exp_f32 v61, v61
    v_exp_f32 v62, v62
    v_exp_f32 v63, v63
    v_mfma_f32_32x32x16_bf16 v[72:87], a[124:127], v[124:127], v[72:87]
    v_cvt_pk_bf16_f32 v106, v60, v61
    v_cvt_pk_bf16_f32 v107, v62, v63
    v_exp_f32 v64, v64
    v_exp_f32 v65, v65
    v_exp_f32 v66, v66
    v_exp_f32 v67, v67
    v_mfma_f32_32x32x16_bf16 v[88:103], a[120:123], v[104:107], v[88:103]
    v_cvt_pk_bf16_f32 v108, v64, v65
    v_cvt_pk_bf16_f32 v109, v66, v67
    v_exp_f32 v68, v68
    v_exp_f32 v69, v69
    v_exp_f32 v70, v70
    v_exp_f32 v71, v71
    v_cvt_pk_bf16_f32 v110, v68, v69
    ds_write_b128 v2, v[72:75] offset:0
    v_cvt_pk_bf16_f32 v111, v70, v71
    v_mfma_f32_32x32x16_bf16 v[56:71], a[16:19], v[24:27], 0
    ds_write_b128 v2, v[76:79] offset:1024
    v_exp_f32 v40, v40
    ds_write_b128 v2, v[80:83] offset:2048
    v_exp_f32 v41, v41
    v_exp_f32 v42, v42
    v_mfma_f32_32x32x16_bf16 v[56:71], a[20:23], v[28:31], v[56:71]
    v_exp_f32 v43, v43
    v_cvt_pk_bf16_f32 v112, v40, v41
    v_cvt_pk_bf16_f32 v113, v42, v43
    v_exp_f32 v44, v44
    ds_write_b128 v2, v[84:87] offset:3072
    v_exp_f32 v45, v45
    v_mfma_f32_32x32x16_bf16 v[88:103], a[124:127], v[108:111], v[88:103]
    v_exp_f32 v46, v46
    v_exp_f32 v47, v47
    v_cvt_pk_bf16_f32 v114, v44, v45
    v_cvt_pk_bf16_f32 v115, v46, v47
    v_exp_f32 v48, v48
    v_exp_f32 v49, v49
    v_mfma_f32_32x32x16_bf16 v[72:87], a[8:11], v[112:115], 0
    v_exp_f32 v50, v50
    v_exp_f32 v51, v51
    v_cvt_pk_bf16_f32 v116, v48, v49
    v_cvt_pk_bf16_f32 v117, v50, v51
    v_exp_f32 v52, v52
    v_exp_f32 v53, v53
    v_exp_f32 v54, v54
    ds_write_b128 v3, v[88:91] offset:0
    v_exp_f32 v55, v55
    s_setprio 0
    v_cvt_pk_bf16_f32 v118, v52, v53
    v_cvt_pk_bf16_f32 v119, v54, v55
    v_mfma_f32_32x32x16_bf16 v[40:55], a[32:35], v[24:27], 0
    v_exp_f32 v56, v56
    ds_write_b128 v3, v[92:95] offset:1024
    v_exp_f32 v57, v57
    v_exp_f32 v58, v58
    v_exp_f32 v59, v59
    v_mfma_f32_32x32x16_bf16 v[40:55], a[36:39], v[28:31], v[40:55]
    v_cvt_pk_bf16_f32 v120, v56, v57
    v_cvt_pk_bf16_f32 v121, v58, v59
    v_exp_f32 v60, v60
    v_exp_f32 v61, v61
    v_exp_f32 v62, v62
    ds_write_b128 v3, v[96:99] offset:2048
    v_exp_f32 v63, v63
    v_mfma_f32_32x32x16_bf16 v[72:87], a[12:15], v[116:119], v[72:87]
    v_cvt_pk_bf16_f32 v122, v60, v61
    v_cvt_pk_bf16_f32 v123, v62, v63
    v_exp_f32 v64, v64
    v_exp_f32 v65, v65
    v_exp_f32 v66, v66
    v_exp_f32 v67, v67
    v_mfma_f32_32x32x16_bf16 v[72:87], a[24:27], v[120:123], v[72:87]
    v_cvt_pk_bf16_f32 v124, v64, v65
    v_cvt_pk_bf16_f32 v125, v66, v67
    v_exp_f32 v68, v68
    ds_write_b128 v3, v[100:103] offset:3072
    v_exp_f32 v69, v69
    s_lshl_b32 s49, s31, 7
    s_add_u32 s49, s49, s69
    s_cmp_eq_u32 s28, 4
    s_cselect_b32 s49, s49, 1073741824
    v_mov_b32 v7, s36
    s_mov_b64 exec, 1
    buffer_store_dword v7, v1, s[12:15], s49 offen sc1
    s_mov_b64 exec, -1
    v_exp_f32 v70, v70
    v_exp_f32 v71, v71
    v_cvt_pk_bf16_f32 v126, v68, v69
    v_cvt_pk_bf16_f32 v127, v70, v71
    v_mfma_f32_32x32x16_bf16 v[56:71], a[48:51], v[24:27], 0
    v_exp_f32 v40, v40
    v_exp_f32 v41, v41
    v_exp_f32 v42, v42
    v_exp_f32 v43, v43
    v_cvt_pk_bf16_f32 v104, v40, v41
    v_mfma_f32_32x32x16_bf16 v[56:71], a[52:55], v[28:31], v[56:71]
    v_cvt_pk_bf16_f32 v105, v42, v43
    v_exp_f32 v44, v44
    v_exp_f32 v45, v45
    v_exp_f32 v46, v46
    v_exp_f32 v47, v47
    v_mfma_f32_32x32x16_bf16 v[72:87], a[28:31], v[124:127], v[72:87]
    v_cvt_pk_bf16_f32 v106, v44, v45
    v_cvt_pk_bf16_f32 v107, v46, v47
    v_exp_f32 v48, v48
    s_waitcnt lgkmcnt(0)
    s_barrier
    v_exp_f32 v49, v49
    ds_read_b128 v[88:91], v4 offset:0
    v_exp_f32 v50, v50
    v_mfma_f32_32x32x16_bf16 v[72:87], a[40:43], v[104:107], v[72:87]
    ds_read_b128 v[92:95], v4 offset:1024
    v_exp_f32 v51, v51
    ds_read_b128 v[96:99], v4 offset:2048
    v_cvt_pk_bf16_f32 v108, v48, v49
    ds_read_b128 v[100:103], v4 offset:3072
    v_cvt_pk_bf16_f32 v109, v50, v51
    v_exp_f32 v52, v52
    v_exp_f32 v53, v53
    v_exp_f32 v54, v54
    v_exp_f32 v55, v55
    s_setprio 3
    v_cvt_pk_bf16_f32 v110, v52, v53
    v_cvt_pk_bf16_f32 v111, v54, v55
    v_mfma_f32_32x32x16_bf16 v[40:55], a[64:67], v[24:27], 0
    v_exp_f32 v56, v56
    s_add_u32 m0, s51, 7168
    s_add_u32 s49, s52, 28672
    buffer_load_dwordx4 v5, s[16:19], s49 offen lds
    v_exp_f32 v57, v57
    v_exp_f32 v58, v58
    v_mfma_f32_32x32x16_bf16 v[40:55], a[68:71], v[28:31], v[40:55]
    v_exp_f32 v59, v59
    v_cvt_pk_bf16_f32 v112, v56, v57
    v_cvt_pk_bf16_f32 v113, v58, v59
    v_exp_f32 v60, v60
    v_exp_f32 v61, v61
    s_add_u32 m0, s51, 14336
    s_add_u32 s49, s52, 57344
    buffer_load_dwordx4 v5, s[16:19], s49 offen lds
    v_exp_f32 v62, v62
    v_mfma_f32_32x32x16_bf16 v[72:87], a[44:47], v[108:111], v[72:87]
    v_exp_f32 v63, v63
    v_cvt_pk_bf16_f32 v114, v60, v61
    v_cvt_pk_bf16_f32 v115, v62, v63
    v_exp_f32 v64, v64
    v_exp_f32 v65, v65
    v_exp_f32 v66, v66
    v_mfma_f32_32x32x16_bf16 v[72:87], a[56:59], v[112:115], v[72:87]
    s_add_u32 m0, s51, 21504
    s_add_u32 s49, s52, 86016
    buffer_load_dwordx4 v5, s[16:19], s49 offen lds
    v_exp_f32 v67, v67
    v_cvt_pk_bf16_f32 v116, v64, v65
    v_cvt_pk_bf16_f32 v117, v66, v67
    v_exp_f32 v68, v68
    v_exp_f32 v69, v69
    v_exp_f32 v70, v70
    v_exp_f32 v71, v71
    v_cvt_pk_bf16_f32 v118, v68, v69
    v_cvt_pk_bf16_f32 v119, v70, v71
    v_mfma_f32_32x32x16_bf16 v[56:71], a[80:83], v[24:27], 0
    v_exp_f32 v40, v40
    v_exp_f32 v41, v41
    v_exp_f32 v42, v42
    v_exp_f32 v43, v43
    v_cvt_pk_bf16_f32 v120, v40, v41
    v_mfma_f32_32x32x16_bf16 v[56:71], a[84:87], v[28:31], v[56:71]
    v_cvt_pk_bf16_f32 v121, v42, v43
    v_exp_f32 v44, v44
    s_waitcnt lgkmcnt(0)
    v_exp_f32 v45, v45
    v_exp_f32 v46, v46
    v_exp_f32 v47, v47
    v_mfma_f32_32x32x16_bf16 v[72:87], a[60:63], v[116:119], v[72:87]
    s_add_u32 m0, s51, 28672
    s_add_u32 s49, s52, 114688
    buffer_load_dwordx4 v5, s[16:19], s49 offen lds
    v_cvt_pk_bf16_f32 v122, v44, v45
    v_cvt_pk_bf16_f32 v123, v46, v47
    v_exp_f32 v48, v48
    v_exp_f32 v49, v49
    v_mfma_f32_32x32x16_bf16 v[88:103], a[72:75], v[120:123], v[88:103]
    v_exp_f32 v50, v50
    v_exp_f32 v51, v51
    v_cvt_pk_bf16_f32 v124, v48, v49
    v_cvt_pk_bf16_f32 v125, v50, v51
    v_exp_f32 v52, v52
    s_add_u32 m0, s51, 35840
    s_add_u32 s49, s52, 143360
    buffer_load_dwordx4 v5, s[16:19], s49 offen lds
    v_exp_f32 v53, v53
    v_exp_f32 v54, v54
    v_exp_f32 v55, v55
    v_cvt_pk_bf16_f32 v126, v52, v53
    v_cvt_pk_bf16_f32 v127, v54, v55
    v_mfma_f32_32x32x16_bf16 v[40:55], a[96:99], v[24:27], 0
    v_exp_f32 v56, v56
    v_exp_f32 v57, v57
    v_exp_f32 v58, v58
    s_add_u32 m0, s51, 43008
    s_add_u32 s49, s52, 172032
    buffer_load_dwordx4 v5, s[16:19], s49 offen lds
    v_exp_f32 v59, v59
    v_mfma_f32_32x32x16_bf16 v[40:55], a[100:103], v[28:31], v[40:55]
    v_cvt_pk_bf16_f32 v104, v56, v57
    v_cvt_pk_bf16_f32 v105, v58, v59
    v_exp_f32 v60, v60
    v_exp_f32 v61, v61
    v_exp_f32 v62, v62
    v_exp_f32 v63, v63
    v_mfma_f32_32x32x16_bf16 v[88:103], a[76:79], v[124:127], v[88:103]
    s_add_u32 m0, s51, 50176
    s_add_u32 s49, s52, 200704
    buffer_load_dwordx4 v5, s[16:19], s49 offen lds
    v_cvt_pk_bf16_f32 v106, v60, v61
    v_cvt_pk_bf16_f32 v107, v62, v63
    v_exp_f32 v64, v64
    v_exp_f32 v65, v65
    v_mfma_f32_32x32x16_bf16 v[88:103], a[88:91], v[104:107], v[88:103]
    v_exp_f32 v66, v66
    v_exp_f32 v67, v67
    v_cvt_pk_bf16_f32 v108, v64, v65
    v_cvt_pk_bf16_f32 v109, v66, v67
    v_exp_f32 v68, v68
    s_add_u32 m0, s51, 57344
    s_add_u32 s49, s52, 229376
    buffer_load_dwordx4 v5, s[16:19], s49 offen lds
    v_exp_f32 v69, v69
    v_exp_f32 v70, v70
    v_exp_f32 v71, v71
    s_setprio 2
    v_cvt_pk_bf16_f32 v110, v68, v69
    v_cvt_pk_bf16_f32 v111, v70, v71
    v_mfma_f32_32x32x16_bf16 v[56:71], a[112:115], v[24:27], 0
    v_exp_f32 v40, v40
    v_exp_f32 v41, v41
    v_exp_f32 v42, v42
    s_add_u32 m0, s51, 64512
    s_add_u32 s49, s52, 258048
    buffer_load_dwordx4 v5, s[16:19], s49 offen lds
    v_exp_f32 v43, v43
    v_mfma_f32_32x32x16_bf16 v[56:71], a[116:119], v[28:31], v[56:71]
    v_cvt_pk_bf16_f32 v112, v40, v41
    v_cvt_pk_bf16_f32 v113, v42, v43
    v_exp_f32 v44, v44
    v_exp_f32 v45, v45
    v_exp_f32 v46, v46
    v_exp_f32 v47, v47
    v_mfma_f32_32x32x16_bf16 v[88:103], a[92:95], v[108:111], v[88:103]
    s_add_u32 m0, s51, 71680
    s_add_u32 s49, s52, 286720
    buffer_load_dwordx4 v5, s[16:19], s49 offen lds
    v_cvt_pk_bf16_f32 v114, v44, v45
    v_cvt_pk_bf16_f32 v115, v46, v47
    v_exp_f32 v48, v48
    v_exp_f32 v49, v49
    v_mfma_f32_32x32x16_bf16 v[88:103], a[104:107], v[112:115], v[88:103]
    v_exp_f32 v50, v50
    v_exp_f32 v51, v51
    v_cvt_pk_bf16_f32 v116, v48, v49
    v_cvt_pk_bf16_f32 v117, v50, v51
    v_exp_f32 v52, v52
    s_add_u32 m0, s51, 78848
    s_add_u32 s49, s52, 315392
    buffer_load_dwordx4 v5, s[16:19], s49 offen lds
    v_exp_f32 v53, v53
    v_exp_f32 v54, v54
    v_exp_f32 v55, v55
    v_cvt_pk_bf16_f32 v118, v52, v53
    v_cvt_pk_bf16_f32 v119, v54, v55
    v_mfma_f32_32x32x16_bf16 v[40:55], a[0:3], v[32:35], 0
    v_exp_f32 v56, v56
    v_exp_f32 v57, v57
    v_exp_f32 v58, v58
    s_add_u32 m0, s51, 86016
    s_add_u32 s49, s52, 344064
    buffer_load_dwordx4 v5, s[16:19], s49 offen lds
    v_exp_f32 v59, v59
    v_mfma_f32_32x32x16_bf16 v[40:55], a[4:7], v[36:39], v[40:55]
    v_cvt_pk_bf16_f32 v120, v56, v57
    v_cvt_pk_bf16_f32 v121, v58, v59
    v_exp_f32 v60, v60
    v_exp_f32 v61, v61
    v_exp_f32 v62, v62
    v_exp_f32 v63, v63
    v_mfma_f32_32x32x16_bf16 v[88:103], a[108:111], v[116:119], v[88:103]
    s_add_u32 m0, s51, 93184
    s_add_u32 s49, s52, 372736
    buffer_load_dwordx4 v5, s[16:19], s49 offen lds
    v_cvt_pk_bf16_f32 v122, v60, v61
    v_cvt_pk_bf16_f32 v123, v62, v63
    v_exp_f32 v64, v64
    v_exp_f32 v65, v65
    v_mfma_f32_32x32x16_bf16 v[88:103], a[120:123], v[120:123], v[88:103]
    v_exp_f32 v66, v66
    v_exp_f32 v67, v67
    v_cvt_pk_bf16_f32 v124, v64, v65
    v_cvt_pk_bf16_f32 v125, v66, v67
    v_exp_f32 v68, v68
    v_exp_f32 v69, v69
    v_exp_f32 v70, v70
    v_exp_f32 v71, v71
    s_setprio 1
    v_cvt_pk_bf16_f32 v126, v68, v69
    v_cvt_pk_bf16_f32 v127, v70, v71
    v_mfma_f32_32x32x16_bf16 v[56:71], a[16:19], v[32:35], 0
    v_exp_f32 v40, v40
    v_exp_f32 v41, v41
    v_exp_f32 v42, v42
    v_exp_f32 v43, v43
    v_cvt_pk_bf16_f32 v104, v40, v41
    v_mfma_f32_32x32x16_bf16 v[56:71], a[20:23], v[36:39], v[56:71]
    v_cvt_pk_bf16_f32 v105, v42, v43
    v_exp_f32 v44, v44
    v_exp_f32 v45, v45
    v_exp_f32 v46, v46
    v_exp_f32 v47, v47
    v_mfma_f32_32x32x16_bf16 v[88:103], a[124:127], v[124:127], v[88:103]
    v_cvt_pk_bf16_f32 v106, v44, v45
    v_cvt_pk_bf16_f32 v107, v46, v47
    v_exp_f32 v48, v48
    v_exp_f32 v49, v49
    v_exp_f32 v50, v50
    v_exp_f32 v51, v51
    v_cvt_pk_bf16_f32 v108, v48, v49
    v_cvt_pk_bf16_f32 v109, v50, v51
    v_exp_f32 v52, v52
    v_exp_f32 v53, v53
    v_exp_f32 v54, v54
    v_exp_f32 v55, v55
    v_cvt_pk_bf16_f32 v110, v52, v53
    v_cvt_pk_bf16_f32 v111, v54, v55
    v_mfma_f32_32x32x16_bf16 v[40:55], a[32:35], v[32:35], 0
    v_pk_add_f32 v[72:73], v[72:73], v[88:89]
    v_exp_f32 v56, v56
    v_pk_add_f32 v[74:75], v[74:75], v[90:91]
    v_exp_f32 v57, v57
    v_pk_add_f32 v[76:77], v[76:77], v[92:93]
    v_exp_f32 v58, v58
    v_mfma_f32_32x32x16_bf16 v[40:55], a[36:39], v[36:39], v[40:55]
    v_pk_add_f32 v[78:79], v[78:79], v[94:95]
    v_exp_f32 v59, v59
    v_pk_add_f32 v[80:81], v[80:81], v[96:97]
    v_cvt_pk_bf16_f32 v112, v56, v57
    v_pk_add_f32 v[82:83], v[82:83], v[98:99]
    v_cvt_pk_bf16_f32 v113, v58, v59
    v_pk_add_f32 v[84:85], v[84:85], v[100:101]
    v_exp_f32 v60, v60
    v_pk_add_f32 v[86:87], v[86:87], v[102:103]
    v_exp_f32 v61, v61
    ds_read_b128 v[88:91], v6 offset:32768
    v_exp_f32 v62, v62
    ds_read_b128 v[92:95], v6 offset:33792
    v_exp_f32 v63, v63
    ds_read_b128 v[96:99], v6 offset:34816
    v_cvt_pk_bf16_f32 v114, v60, v61
    ds_read_b128 v[100:103], v6 offset:35840
    v_cvt_pk_bf16_f32 v115, v62, v63
    ds_write_b128 v4, v[72:75]
    v_exp_f32 v64, v64
    v_exp_f32 v65, v65
    v_exp_f32 v66, v66
    v_exp_f32 v67, v67
    v_cvt_pk_bf16_f32 v116, v64, v65
    v_cvt_pk_bf16_f32 v117, v66, v67
    v_exp_f32 v68, v68
    v_exp_f32 v69, v69
    v_exp_f32 v70, v70
    v_exp_f32 v71, v71
    s_waitcnt lgkmcnt(1)
    s_setprio 0
    v_mfma_f32_32x32x16_bf16 v[88:103], a[8:11], v[104:107], v[88:103]
    ds_write_b128 v4, v[76:79] offset:1024
    v_cvt_pk_bf16_f32 v118, v68, v69
    v_cvt_pk_bf16_f32 v119, v70, v71
    v_exp_f32 v40, v40
    v_exp_f32 v41, v41
    v_exp_f32 v42, v42
    v_mfma_f32_32x32x16_bf16 v[56:71], a[48:51], v[32:35], 0
    ds_write_b128 v4, v[80:83] offset:2048
    v_exp_f32 v43, v43
    v_cvt_pk_bf16_f32 v120, v40, v41
    v_cvt_pk_bf16_f32 v121, v42, v43
    v_mfma_f32_32x32x16_bf16 v[56:71], a[52:55], v[36:39], v[56:71]
    v_exp_f32 v44, v44
    v_exp_f32 v45, v45
    v_exp_f32 v46, v46
    v_mfma_f32_32x32x16_bf16 v[88:103], a[12:15], v[108:111], v[88:103]
    v_exp_f32 v47, v47
    ds_write_b128 v4, v[84:87] offset:3072
    v_cvt_pk_bf16_f32 v122, v44, v45
    v_cvt_pk_bf16_f32 v123, v46, v47
    v_mfma_f32_32x32x16_bf16 v[88:103], a[24:27], v[112:115], v[88:103]
    v_exp_f32 v48, v48
    v_exp_f32 v49, v49
    v_exp_f32 v50, v50
    v_exp_f32 v51, v51
    v_cvt_pk_bf16_f32 v124, v48, v49
    v_mfma_f32_32x32x16_bf16 v[88:103], a[28:31], v[116:119], v[88:103]
    v_cvt_pk_bf16_f32 v125, v50, v51
    v_exp_f32 v52, v52
    s_waitcnt lgkmcnt(0)
    s_barrier
    v_exp_f32 v53, v53
    ds_read_b128 v[72:75], v6 offset:0
    v_exp_f32 v54, v54
    v_mfma_f32_32x32x16_bf16 v[88:103], a[40:43], v[120:123], v[88:103]
    ds_read_b128 v[76:79], v6 offset:1024
    v_exp_f32 v55, v55
    ds_read_b128 v[80:83], v6 offset:2048
    s_setprio 3
    ds_read_b128 v[84:87], v6 offset:3072
    v_cvt_pk_bf16_f32 v126, v52, v53
    s_add_u32 m0, s51, 0
    s_add_u32 s49, s52, 0
    buffer_load_dwordx4 v5, s[16:19], s49 offen lds
    v_cvt_pk_bf16_f32 v127, v54, v55
    v_mfma_f32_32x32x16_bf16 v[40:55], a[64:67], v[32:35], 0
    v_exp_f32 v56, v56
    v_exp_f32 v57, v57
    v_exp_f32 v58, v58
    v_exp_f32 v59, v59
    v_cvt_pk_bf16_f32 v104, v56, v57
    v_mfma_f32_32x32x16_bf16 v[40:55], a[68:71], v[36:39], v[40:55]
    v_cvt_pk_bf16_f32 v105, v58, v59
    v_exp_f32 v60, v60
    v_exp_f32 v61, v61
    v_exp_f32 v62, v62
    v_exp_f32 v63, v63
    v_mfma_f32_32x32x16_bf16 v[88:103], a[44:47], v[124:127], v[88:103]
    v_cvt_pk_bf16_f32 v106, v60, v61
    v_cvt_pk_bf16_f32 v107, v62, v63
    v_exp_f32 v64, v64
    v_exp_f32 v65, v65
    v_exp_f32 v66, v66
    v_exp_f32 v67, v67
    v_mfma_f32_32x32x16_bf16 v[88:103], a[56:59], v[104:107], v[88:103]
    v_cvt_pk_bf16_f32 v108, v64, v65
    v_cvt_pk_bf16_f32 v109, v66, v67
    v_exp_f32 v68, v68
    v_exp_f32 v69, v69
    v_exp_f32 v70, v70
    v_exp_f32 v71, v71
    v_cvt_pk_bf16_f32 v110, v68, v69
    v_cvt_pk_bf16_f32 v111, v70, v71
    v_mfma_f32_32x32x16_bf16 v[56:71], a[80:83], v[32:35], 0
    v_exp_f32 v40, v40
    v_exp_f32 v41, v41
    v_exp_f32 v42, v42
    v_exp_f32 v43, v43
    v_cvt_pk_bf16_f32 v112, v40, v41
    v_mfma_f32_32x32x16_bf16 v[56:71], a[84:87], v[36:39], v[56:71]
    v_cvt_pk_bf16_f32 v113, v42, v43
    v_exp_f32 v44, v44
    s_waitcnt lgkmcnt(0)
    v_exp_f32 v45, v45
    v_exp_f32 v46, v46
    v_exp_f32 v47, v47
    v_mfma_f32_32x32x16_bf16 v[88:103], a[60:63], v[108:111], v[88:103]
    v_cvt_pk_bf16_f32 v114, v44, v45
    v_cvt_pk_bf16_f32 v115, v46, v47
    v_exp_f32 v48, v48
    v_exp_f32 v49, v49
    v_exp_f32 v50, v50
    v_exp_f32 v51, v51
    v_mfma_f32_32x32x16_bf16 v[72:87], a[72:75], v[112:115], v[72:87]
    v_cvt_pk_bf16_f32 v116, v48, v49
    v_cvt_pk_bf16_f32 v117, v50, v51
    v_exp_f32 v52, v52
    v_exp_f32 v53, v53
    v_exp_f32 v54, v54
    v_exp_f32 v55, v55
    s_setprio 2
    v_cvt_pk_bf16_f32 v118, v52, v53
    v_cvt_pk_bf16_f32 v119, v54, v55
    v_mfma_f32_32x32x16_bf16 v[40:55], a[96:99], v[32:35], 0
    v_exp_f32 v56, v56
    s_lshl_b32 s50, s28, 8
    s_add_u32 s50, s50, s69
    s_mov_b64 exec, 0x101
    buffer_load_dword v7, v1, s[12:15], s50 offen sc1
    s_mov_b64 exec, -1
    v_exp_f32 v57, v57
    v_mfma_f32_32x32x16_bf16 v[40:55], a[100:103], v[36:39], v[40:55]
    v_exp_f32 v58, v58
    v_exp_f32 v59, v59
    v_cvt_pk_bf16_f32 v120, v56, v57
    v_cvt_pk_bf16_f32 v121, v58, v59
    v_exp_f32 v60, v60
    v_exp_f32 v61, v61
    v_mfma_f32_32x32x16_bf16 v[72:87], a[76:79], v[116:119], v[72:87]
    v_exp_f32 v62, v62
    v_exp_f32 v63, v63
    v_cvt_pk_bf16_f32 v122, v60, v61
    v_cvt_pk_bf16_f32 v123, v62, v63
    v_exp_f32 v64, v64
    v_exp_f32 v65, v65
    v_mfma_f32_32x32x16_bf16 v[72:87], a[88:91], v[120:123], v[72:87]
    v_exp_f32 v66, v66
    v_exp_f32 v67, v67
    v_cvt_pk_bf16_f32 v124, v64, v65
    v_cvt_pk_bf16_f32 v125, v66, v67
    v_exp_f32 v68, v68
    v_exp_f32 v69, v69
    v_exp_f32 v70, v70
    v_exp_f32 v71, v71
    s_setprio 1
    v_cvt_pk_bf16_f32 v126, v68, v69
    v_cvt_pk_bf16_f32 v127, v70, v71
    v_mfma_f32_32x32x16_bf16 v[56:71], a[112:115], v[32:35], 0
    v_exp_f32 v40, v40
    v_exp_f32 v41, v41
    v_exp_f32 v42, v42
    v_exp_f32 v43, v43
    v_cvt_pk_bf16_f32 v104, v40, v41
    v_mfma_f32_32x32x16_bf16 v[56:71], a[116:119], v[36:39], v[56:71]
    v_cvt_pk_bf16_f32 v105, v42, v43
    v_exp_f32 v44, v44
    v_exp_f32 v45, v45
    v_exp_f32 v46, v46
    v_mfma_f32_32x32x16_bf16 v[72:87], a[92:95], v[124:127], v[72:87]
    v_exp_f32 v47, v47
    v_cvt_pk_bf16_f32 v106, v44, v45
    v_cvt_pk_bf16_f32 v107, v46, v47
    v_exp_f32 v48, v48
    v_exp_f32 v49, v49
    v_mfma_f32_32x32x16_bf16 v[72:87], a[104:107], v[104:107], v[72:87]
    v_exp_f32 v50, v50
    v_exp_f32 v51, v51
    v_cvt_pk_bf16_f32 v108, v48, v49
    v_cvt_pk_bf16_f32 v109, v50, v51
    v_exp_f32 v52, v52
    v_exp_f32 v53, v53
    v_exp_f32 v54, v54
    v_exp_f32 v55, v55
    s_setprio 0
    v_cvt_pk_bf16_f32 v110, v52, v53
    v_cvt_pk_bf16_f32 v111, v54, v55
    v_exp_f32 v56, v56
    v_exp_f32 v57, v57
    v_mfma_f32_32x32x16_bf16 v[72:87], a[108:111], v[108:111], v[72:87]
    v_exp_f32 v58, v58
    v_exp_f32 v59, v59
    v_cvt_pk_bf16_f32 v112, v56, v57
    v_cvt_pk_bf16_f32 v113, v58, v59
    v_exp_f32 v60, v60
    v_exp_f32 v61, v61
    v_exp_f32 v62, v62
    v_exp_f32 v63, v63
    v_cvt_pk_bf16_f32 v114, v60, v61
    v_cvt_pk_bf16_f32 v115, v62, v63
    v_exp_f32 v64, v64
    s_waitcnt vmcnt(0)
    s_mov_b64 exec, 0x101
    v_cmp_ne_u32 s[70:71], s36, v7
    s_mov_b64 exec, -1
    v_exp_f32 v65, v65
    v_mfma_f32_32x32x16_bf16 v[72:87], a[120:123], v[112:115], v[72:87]
    v_exp_f32 v66, v66
    v_exp_f32 v67, v67
    v_cvt_pk_bf16_f32 v116, v64, v65
    v_cvt_pk_bf16_f32 v117, v66, v67
    v_exp_f32 v68, v68
    v_exp_f32 v69, v69
    v_exp_f32 v70, v70
    v_exp_f32 v71, v71
    v_cvt_pk_bf16_f32 v118, v68, v69
    v_cvt_pk_bf16_f32 v119, v70, v71
    s_nop 0
    s_nop 0
    v_mfma_f32_32x32x16_bf16 v[72:87], a[124:127], v[116:119], v[72:87]
    v_xor_b32 v7, 16384, v6
    v_lshrrev_b32 v2, 2, v1
    v_sub_u32 v2, v2, v1
    v_add_u32 v3, v2, v7
    v_add_u32 v2, v2, v6
    s_lshr_b32 s58, s31, 2
    s_lshl_b32 s59, s32, 2
    s_add_u32 s53, s58, s59
    s_lshl_b32 s59, s53, 15
    s_lshl_b32 s60, s28, 12
    s_add_u32 s59, s59, s60
    s_add_u32 s54, s59, 6291456
    v_mov_b32 v45, 0x71800000
    v_mov_b32 v46, 0x30800000

    s_cmp_lg_u32 s29, 0
    s_cbranch_scc1 L_g1
    v_pk_add_f32 v[80:81], v[80:81], v[96:97]
    v_pk_add_f32 v[82:83], v[82:83], v[98:99]
    v_pk_add_f32 v[84:85], v[84:85], v[100:101]
    v_pk_add_f32 v[86:87], v[86:87], v[102:103]
    ds_write_b128 v6, v[80:83]
    ds_write_b128 v6, v[84:87] offset:1024
    v_pk_add_f32 v[72:73], v[72:73], v[88:89]
    v_pk_add_f32 v[74:75], v[74:75], v[90:91]
    v_pk_add_f32 v[76:77], v[76:77], v[92:93]
    v_pk_add_f32 v[78:79], v[78:79], v[94:95]
    s_waitcnt lgkmcnt(0)
    s_barrier
    ds_read_b32 v64, v3 offset:2048
    ds_read_b128 v[56:59], v7
    ds_read_b128 v[60:63], v7 offset:1024
    s_waitcnt lgkmcnt(2)
    v_add_f32 v40, v84, v64
    s_waitcnt lgkmcnt(0)

    v_pk_add_f32 v[56:57], v[56:57], v[72:73]
    v_pk_add_f32 v[58:59], v[58:59], v[74:75]
    v_pk_add_f32 v[60:61], v[60:61], v[76:77]
    v_pk_add_f32 v[62:63], v[62:63], v[78:79]
    s_branch L_fin
L_g1:
    v_pk_add_f32 v[72:73], v[72:73], v[88:89]
    v_pk_add_f32 v[74:75], v[74:75], v[90:91]
    v_pk_add_f32 v[76:77], v[76:77], v[92:93]
    v_pk_add_f32 v[78:79], v[78:79], v[94:95]
    v_pk_add_f32 v[84:85], v[84:85], v[100:101]
    ds_write_b128 v6, v[72:75]
    ds_write_b128 v6, v[76:79] offset:1024
    ds_write_b32 v2, v84 offset:2048

    v_pk_add_f32 v[80:81], v[80:81], v[96:97]
    v_pk_add_f32 v[82:83], v[82:83], v[98:99]
    v_pk_add_f32 v[86:87], v[86:87], v[102:103]
    s_waitcnt lgkmcnt(0)
    s_barrier
    ds_read_b128 v[60:63], v7 offset:1024
    ds_read_b128 v[56:59], v7
    s_waitcnt lgkmcnt(1)
    v_add_f32 v40, v84, v60
    s_waitcnt lgkmcnt(0)

    v_pk_add_f32 v[56:57], v[56:57], v[80:81]
    v_pk_add_f32 v[58:59], v[58:59], v[82:83]
    v_pk_add_f32 v[60:61], v[60:61], v[84:85]
    v_pk_add_f32 v[62:63], v[62:63], v[86:87]
L_fin:
    v_mov_b32 v41, v40
    v_max3_f32 v43, |v56|, |v57|, |v58|
    v_max3_f32 v43, |v59|, |v60|, v43
    v_permlane32_swap_b32 v40, v41
    v_max3_f32 v43, |v61|, |v62|, v43
    v_max_f32 v43, |v63|, v43
    v_rcp_f32 v42, v41
    v_pk_add_f32 v[48:49], v[56:57], v[58:59]
    v_pk_add_f32 v[50:51], v[60:61], v[62:63]
    v_pk_add_f32 v[48:49], v[48:49], v[50:51]
    v_cmp_lt_f32 vcc, v41, v45
    v_cmp_gt_f32 s[58:59], v41, v46
    v_cmp_lt_f32 s[60:61], v43, v45
    v_cmp_o_f32 s[62:63], v48, v49
    s_and_b64 s[58:59], s[58:59], vcc
    s_and_b64 s[60:61], s[60:61], s[62:63]
    s_and_b64 s[58:59], s[58:59], s[60:61]
    s_cmp_eq_u64 s[58:59], -1
    s_cbranch_scc0 L_slow

L_store:
    v_mul_f32 v56, v56, v42
    v_mul_f32 v57, v57, v42
    v_mul_f32 v58, v58, v42
    v_mul_f32 v59, v59, v42
    v_mul_f32 v60, v60, v42
    v_mul_f32 v61, v61, v42
    v_mul_f32 v62, v62, v42
    v_mul_f32 v63, v63, v42
    v_cvt_pk_bf16_f32 v104, v56, v57
    v_cvt_pk_bf16_f32 v105, v58, v59
    v_cvt_pk_bf16_f32 v106, v60, v61
    v_cvt_pk_bf16_f32 v107, v62, v63
    v_min_u32 v104, 0xfffffffe, v104
    v_min_u32 v105, 0xfffffffe, v105
    v_min_u32 v106, 0xfffffffe, v106
    v_min_u32 v107, 0xfffffffe, v107
    s_cmp_eq_u32 s29, 0
    s_cbranch_scc1 L_st
    s_mov_b64 exec, s[38:39]
    v_mov_b32 v106, 0
    v_mov_b32 v107, 0
    s_mov_b64 exec, -1

L_st:
    buffer_store_dwordx4 v[104:107], v1, s[12:15], s68 offen sc1
    v_lshrrev_b32 v111, 4, v1
    v_bfe_u32 v2, v111, 2, 2
    v_bfe_u32 v3, v111, 4, 1
    v_lshl_add_u32 v2, v3, 2, v2
    v_lshrrev_b32 v3, 5, v111
    v_lshl_add_u32 v2, v3, 4, v2
    v_mul_u32_u24 v2, 224, v2
    v_and_b32 v3, 3, v111
    v_lshl_add_u32 v2, v3, 3, v2
    s_mul_i32 s60, s30, 56
    s_add_u32 s60, s60, 61440
    v_add_u32 v2, s60, v2
    v_add_u32 v6, 50176, v2
    v_and_b32 v3, 15, v111
    v_lshrrev_b32 v4, 4, v111
    v_lshlrev_b32 v4, 9, v4
    v_lshl_add_u32 v3, v3, 4, v4
    s_lshl_b32 s60, s29, 8
    s_add_u32 s60, s60, 0
    v_add_u32 v3, s60, v3
    s_lshl_b32 s60, s28, 12
    s_add_u32 s60, s60, 0
    v_add_u32 v7, s60, v1
    v_and_b32 v113, 3, v111
    v_lshlrev_b32 v113, 10, v113
    v_add_u32 v113, 1020, v113

    s_waitcnt vmcnt(1)
    s_barrier
    s_cmp_eq_u64 s[70:71], 0
    s_cbranch_scc1 L_fr_done
    s_mov_b32 s61, 0
    s_mov_b64 exec, 0x101

L_fr:
    buffer_load_dword v114, v1, s[12:15], s50 offen sc1
    s_add_u32 s61, s61, 1
    s_waitcnt vmcnt(0)
    v_cmp_ne_u32 vcc, s36, v114
    s_cmp_gt_u32 s61, 20000
    s_cbranch_scc1 L_fr_done
    s_cbranch_vccnz L_fr

L_fr_done:
    s_mov_b64 exec, -1
    s_mov_b32 s61, 0
    s_mov_b64 exec, 15
    buffer_load_dword v114, v113, s[12:15], s54 offen sc1
    s_mov_b64 exec, -1

    ds_read_b64_tr_b16 v[8:9], v2 offset:0
    ds_read_b64_tr_b16 v[10:11], v2 offset:1792
    ds_read_b64_tr_b16 v[12:13], v2 offset:32
    ds_read_b64_tr_b16 v[14:15], v2 offset:1824
    ds_read_b64_tr_b16 v[16:17], v2 offset:6272
    ds_read_b64_tr_b16 v[18:19], v2 offset:8064
    ds_read_b64_tr_b16 v[20:21], v2 offset:6304
    ds_read_b64_tr_b16 v[22:23], v2 offset:8096
    s_waitcnt lgkmcnt(4)
    ds_read_b64_tr_b16 v[24:25], v2 offset:12544
    ds_read_b64_tr_b16 v[26:27], v2 offset:14336
    ds_read_b64_tr_b16 v[28:29], v2 offset:12576
    ds_read_b64_tr_b16 v[30:31], v2 offset:14368
    ds_read_b64_tr_b16 v[32:33], v2 offset:18816
    ds_read_b64_tr_b16 v[34:35], v2 offset:20608
    ds_read_b64_tr_b16 v[36:37], v2 offset:18848
    ds_read_b64_tr_b16 v[38:39], v2 offset:20640
    s_waitcnt lgkmcnt(4)
    ds_read_b64_tr_b16 v[40:41], v2 offset:25088
    ds_read_b64_tr_b16 v[42:43], v2 offset:26880
    ds_read_b64_tr_b16 v[44:45], v2 offset:25120
    ds_read_b64_tr_b16 v[46:47], v2 offset:26912
    ds_read_b64_tr_b16 v[48:49], v2 offset:31360
    ds_read_b64_tr_b16 v[50:51], v2 offset:33152
    ds_read_b64_tr_b16 v[52:53], v2 offset:31392
    ds_read_b64_tr_b16 v[54:55], v2 offset:33184
    s_waitcnt lgkmcnt(4)
    ds_read_b64_tr_b16 v[56:57], v2 offset:37632
    ds_read_b64_tr_b16 v[58:59], v2 offset:39424
    ds_read_b64_tr_b16 v[60:61], v2 offset:37664
    ds_read_b64_tr_b16 v[62:63], v2 offset:39456
    ds_read_b64_tr_b16 v[64:65], v2 offset:43904
    ds_read_b64_tr_b16 v[66:67], v2 offset:45696
    ds_read_b64_tr_b16 v[68:69], v2 offset:43936
    ds_read_b64_tr_b16 v[70:71], v2 offset:45728
    s_waitcnt lgkmcnt(4)
    ds_read_b64_tr_b16 a[64:65], v6 offset:0
    ds_read_b64_tr_b16 a[66:67], v6 offset:1792
    ds_read_b64_tr_b16 a[68:69], v6 offset:32
    ds_read_b64_tr_b16 a[70:71], v6 offset:1824
    ds_read_b64_tr_b16 a[72:73], v6 offset:6272
    ds_read_b64_tr_b16 a[74:75], v6 offset:8064
    ds_read_b64_tr_b16 a[76:77], v6 offset:6304
    ds_read_b64_tr_b16 a[78:79], v6 offset:8096
    s_waitcnt lgkmcnt(4)
    ds_read_b64_tr_b16 a[80:81], v6 offset:12544
    ds_read_b64_tr_b16 a[82:83], v6 offset:14336
    ds_read_b64_tr_b16 a[84:85], v6 offset:12576
    ds_read_b64_tr_b16 a[86:87], v6 offset:14368
    ds_read_b64_tr_b16 a[88:89], v6 offset:18816
    ds_read_b64_tr_b16 a[90:91], v6 offset:20608
    ds_read_b64_tr_b16 a[92:93], v6 offset:18848
    ds_read_b64_tr_b16 a[94:95], v6 offset:20640
    s_waitcnt lgkmcnt(4)
    ds_read_b64_tr_b16 a[96:97], v6 offset:25088
    ds_read_b64_tr_b16 a[98:99], v6 offset:26880
    ds_read_b64_tr_b16 a[100:101], v6 offset:25120
    ds_read_b64_tr_b16 a[102:103], v6 offset:26912
    ds_read_b64_tr_b16 a[104:105], v6 offset:31360
    ds_read_b64_tr_b16 a[106:107], v6 offset:33152
    ds_read_b64_tr_b16 a[108:109], v6 offset:31392
    ds_read_b64_tr_b16 a[110:111], v6 offset:33184
    s_waitcnt lgkmcnt(4)
    ds_read_b64_tr_b16 a[112:113], v6 offset:37632
    ds_read_b64_tr_b16 a[114:115], v6 offset:39424
    ds_read_b64_tr_b16 a[116:117], v6 offset:37664
    ds_read_b64_tr_b16 a[118:119], v6 offset:39456
    ds_read_b64_tr_b16 a[120:121], v6 offset:43904
    ds_read_b64_tr_b16 a[122:123], v6 offset:45696
    ds_read_b64_tr_b16 a[124:125], v6 offset:43936
    ds_read_b64_tr_b16 a[126:127], v6 offset:45728
    s_waitcnt lgkmcnt(4)
    s_mul_i32 s60, s53, 28672
    s_add_u32 s60, s60, s66
    s_cmp_eq_u32 s28, 7
    s_cselect_b32 s60, 1073741824, s60
    v_and_b32 v4, 15, v111
    s_lshl_b32 s62, s29, 4
    v_add_u32 v4, s62, v4
    v_mul_u32_u24 v4, 224, v4
    v_lshrrev_b32 v2, 4, v111
    v_lshl_add_u32 v4, v2, 3, v4
    s_mul_i32 s62, s30, 56
    s_add_u32 s62, s62, 32768
    v_add_u32 v4, s62, v4
    s_lshl_b32 s62, s28, 10
    s_add_u32 s62, s62, 32768
    v_add_u32 v6, s62, v1
    s_mov_b32 s62, -1
    s_mov_b32 s63, 0x0000ffff

    s_mov_b64 exec, 15
    s_branch L_hint_chk

L_hint:
    buffer_load_dword v114, v113, s[12:15], s54 offen sc1
L_hint_chk:
    s_add_u32 s61, s61, 1
    s_waitcnt vmcnt(0)
    v_cmp_eq_u32 vcc, -1, v114
    s_cmp_gt_u32 s61, 20000
    s_cbranch_scc1 L_hint_done
    s_and_b64 exec, exec, vcc
    s_cbranch_scc1 L_hint

L_hint_done:
    s_mov_b64 exec, -1
L_pollB:
    buffer_load_dwordx4 v[72:75], v1, s[12:15], s54 offen offset:0 sc1
    buffer_load_dwordx4 v[76:79], v1, s[12:15], s54 offen offset:1024 sc1
    buffer_load_dwordx4 v[80:83], v1, s[12:15], s54 offen offset:2048 sc1
    buffer_load_dwordx4 v[84:87], v1, s[12:15], s54 offen offset:3072 sc1
    s_add_u32 s61, s61, 1
    s_waitcnt vmcnt(0)
    v_max3_u32 v112, v72, v73, v74

    v_max3_u32 v112, v75, v76, v112
    v_max3_u32 v112, v77, v78, v112
    v_max3_u32 v112, v79, v80, v112
    v_max3_u32 v112, v81, v82, v112
    v_max3_u32 v112, v83, v84, v112
    v_max3_u32 v112, v85, v86, v112
    v_max_u32 v112, v87, v112
    v_cmp_eq_u32 vcc, -1, v112
    s_cmp_gt_u32 s61, 20000
    s_cbranch_scc1 L_pollB_done
    s_cbranch_vccnz L_pollB

L_pollB_done:
    ds_write_b128 v7, v[72:75] offset:0
    ds_write_b128 v7, v[76:79] offset:1024
    ds_write_b128 v7, v[80:83] offset:2048
    ds_write_b128 v7, v[84:87] offset:3072
    s_waitcnt lgkmcnt(0)
    s_barrier
    ds_read_b128 a[0:3], v3 offset:0
    ds_read_b128 a[4:7], v3 offset:2048
    ds_read_b128 a[8:11], v3 offset:4096
    ds_read_b128 a[12:15], v3 offset:6144
    ds_read_b128 a[16:19], v3 offset:8192
    s_waitcnt lgkmcnt(4)
    v_mfma_f32_16x16x32_bf16 v[88:91], v[8:11], a[0:3], 0
    v_mfma_f32_16x16x32_bf16 v[92:95], v[12:15], a[0:3], 0
    ds_read_b128 a[20:23], v3 offset:10240
    s_waitcnt lgkmcnt(4)
    v_mfma_f32_16x16x32_bf16 v[88:91], v[16:19], a[4:7], v[88:91]
    v_mfma_f32_16x16x32_bf16 v[92:95], v[20:23], a[4:7], v[92:95]
    ds_read_b128 a[24:27], v3 offset:12288
    s_waitcnt lgkmcnt(4)
    v_mfma_f32_16x16x32_bf16 v[88:91], v[24:27], a[8:11], v[88:91]
    v_mfma_f32_16x16x32_bf16 v[92:95], v[28:31], a[8:11], v[92:95]
    ds_read_b128 a[28:31], v3 offset:14336
    s_waitcnt lgkmcnt(4)
    v_mfma_f32_16x16x32_bf16 v[88:91], v[32:35], a[12:15], v[88:91]
    v_mfma_f32_16x16x32_bf16 v[92:95], v[36:39], a[12:15], v[92:95]
    ds_read_b128 a[32:35], v3 offset:16384
    s_waitcnt lgkmcnt(4)
    v_mfma_f32_16x16x32_bf16 v[88:91], v[40:43], a[16:19], v[88:91]
    v_mfma_f32_16x16x32_bf16 v[92:95], v[44:47], a[16:19], v[92:95]
    ds_read_b128 a[36:39], v3 offset:18432
    s_waitcnt lgkmcnt(4)
    v_mfma_f32_16x16x32_bf16 v[88:91], v[48:51], a[20:23], v[88:91]
    v_mfma_f32_16x16x32_bf16 v[92:95], v[52:55], a[20:23], v[92:95]
    ds_read_b128 a[40:43], v3 offset:20480
    s_waitcnt lgkmcnt(4)
    v_mfma_f32_16x16x32_bf16 v[88:91], v[56:59], a[24:27], v[88:91]
    v_mfma_f32_16x16x32_bf16 v[92:95], v[60:63], a[24:27], v[92:95]
    ds_read_b128 a[44:47], v3 offset:22528
    s_waitcnt lgkmcnt(4)
    v_mfma_f32_16x16x32_bf16 v[88:91], v[64:67], a[28:31], v[88:91]
    v_mfma_f32_16x16x32_bf16 v[92:95], v[68:71], a[28:31], v[92:95]
    ds_read_b128 a[48:51], v3 offset:24576
    s_waitcnt lgkmcnt(4)
    v_mfma_f32_16x16x32_bf16 v[88:91], a[64:67], a[32:35], v[88:91]
    v_mfma_f32_16x16x32_bf16 v[92:95], a[68:71], a[32:35], v[92:95]
    ds_read_b128 a[52:55], v3 offset:26624
    s_waitcnt lgkmcnt(4)
    v_mfma_f32_16x16x32_bf16 v[88:91], a[72:75], a[36:39], v[88:91]
    v_mfma_f32_16x16x32_bf16 v[92:95], a[76:79], a[36:39], v[92:95]
    ds_read_b128 a[56:59], v3 offset:28672
    s_waitcnt lgkmcnt(4)
    v_mfma_f32_16x16x32_bf16 v[88:91], a[80:83], a[40:43], v[88:91]
    v_mfma_f32_16x16x32_bf16 v[92:95], a[84:87], a[40:43], v[92:95]
    ds_read_b128 a[60:63], v3 offset:30720
    s_waitcnt lgkmcnt(4)
    v_mfma_f32_16x16x32_bf16 v[88:91], a[88:91], a[44:47], v[88:91]
    v_mfma_f32_16x16x32_bf16 v[92:95], a[92:95], a[44:47], v[92:95]
    s_waitcnt lgkmcnt(3)
    v_mfma_f32_16x16x32_bf16 v[88:91], a[96:99], a[48:51], v[88:91]
    v_mfma_f32_16x16x32_bf16 v[92:95], a[100:103], a[48:51], v[92:95]
    s_waitcnt lgkmcnt(2)
    v_mfma_f32_16x16x32_bf16 v[88:91], a[104:107], a[52:55], v[88:91]
    v_mfma_f32_16x16x32_bf16 v[92:95], a[108:111], a[52:55], v[92:95]
    s_waitcnt lgkmcnt(1)
    v_mfma_f32_16x16x32_bf16 v[88:91], a[112:115], a[56:59], v[88:91]
    v_mfma_f32_16x16x32_bf16 v[92:95], a[116:119], a[56:59], v[92:95]
    s_waitcnt lgkmcnt(0)
    v_mfma_f32_16x16x32_bf16 v[88:91], a[120:123], a[60:63], v[88:91]
    v_mfma_f32_16x16x32_bf16 v[92:95], a[124:127], a[60:63], v[92:95]
    s_nop 6
    v_cvt_pk_bf16_f32 v96, v88, v89
    v_cvt_pk_bf16_f32 v97, v90, v91
    v_cvt_pk_bf16_f32 v98, v92, v93
    v_cvt_pk_bf16_f32 v99, v94, v95
    ds_write_b64 v4, v[96:97]
    s_mov_b64 exec, s[62:63]
    ds_write_b64 v4, v[98:99] offset:32
    s_mov_b64 exec, -1
    s_waitcnt lgkmcnt(0)
    s_barrier
    ds_read_b128 v[88:91], v6
    s_waitcnt lgkmcnt(0)
    buffer_store_dwordx4 v[88:91], v5, s[20:23], s60 offen
    s_endpgm

L_slow:
    s_mov_b64 exec, s[38:39]
    v_mov_b32 v38, 0
    s_mov_b64 exec, -1
    v_mov_b32 v3, 0xff800000
    s_mov_b32 s58, s42
    s_mov_b32 s59, 0

L_slow1:
    buffer_load_dwordx4 v[8:11], v1, s[12:15], s58 offen sc1
    buffer_load_dwordx4 v[12:15], v1, s[12:15], s58 offen offset:1024 sc1
    s_waitcnt vmcnt(0)
    v_mfma_f32_32x32x16_bf16 v[40:55], v[8:11], v[32:35], 0
    v_mfma_f32_32x32x16_bf16 v[40:55], v[12:15], v[36:39], v[40:55]
    s_nop 15

    v_max3_f32 v3, v40, v41, v3
    v_max3_f32 v3, v42, v43, v3
    v_max3_f32 v3, v44, v45, v3
    v_max3_f32 v3, v46, v47, v3
    v_max3_f32 v3, v48, v49, v3
    v_max3_f32 v3, v50, v51, v3
    v_max3_f32 v3, v52, v53, v3
    v_max3_f32 v3, v54, v55, v3
    s_add_u32 s58, s58, 4096
    s_add_u32 s59, s59, 1
    s_cmp_lt_u32 s59, 64
    s_cbranch_scc1 L_slow1
    v_mov_b32 v4, v3
    s_nop 1
    v_permlane32_swap_b32 v3, v4
    s_nop 1
    v_max_f32 v3, v3, v4
    s_mov_b32 s58, s42
    s_mov_b32 s59, 0

    v_mov_b32 v72, 0
    v_mov_b32 v73, 0
    v_mov_b32 v74, 0
    v_mov_b32 v75, 0
    v_mov_b32 v76, 0
    v_mov_b32 v77, 0
    v_mov_b32 v78, 0
    v_mov_b32 v79, 0
    v_mov_b32 v80, 0
    v_mov_b32 v81, 0
    v_mov_b32 v82, 0
    v_mov_b32 v83, 0
    v_mov_b32 v84, 0
    v_mov_b32 v85, 0
    v_mov_b32 v86, 0
    v_mov_b32 v87, 0
L_slow2:
    buffer_load_dwordx4 v[8:11], v1, s[12:15], s58 offen sc1
    buffer_load_dwordx4 v[12:15], v1, s[12:15], s58 offen offset:1024 sc1
    s_mov_b64 exec, s[40:41]
    buffer_load_dwordx4 a[8:11], v1, s[12:15], s58 offen offset:2048 sc1
    buffer_load_dwordx4 a[12:15], v1, s[12:15], s58 offen offset:3072 sc1
    s_mov_b64 exec, -1
    s_waitcnt vmcnt(0)
    v_mfma_f32_32x32x16_bf16 v[40:55], v[8:11], v[32:35], 0
    v_mfma_f32_32x32x16_bf16 v[40:55], v[12:15], v[36:39], v[40:55]
    s_nop 15

    v_sub_f32 v40, v40, v3
    v_sub_f32 v41, v41, v3
    v_sub_f32 v42, v42, v3
    v_sub_f32 v43, v43, v3
    v_sub_f32 v44, v44, v3
    v_sub_f32 v45, v45, v3
    v_sub_f32 v46, v46, v3
    v_sub_f32 v47, v47, v3
    v_sub_f32 v48, v48, v3
    v_sub_f32 v49, v49, v3
    v_sub_f32 v50, v50, v3
    v_sub_f32 v51, v51, v3
    v_sub_f32 v52, v52, v3
    v_sub_f32 v53, v53, v3
    v_sub_f32 v54, v54, v3
    v_sub_f32 v55, v55, v3
    v_exp_f32 v56, v40
    v_exp_f32 v57, v41
    v_exp_f32 v58, v42
    v_exp_f32 v59, v43
    v_exp_f32 v60, v44
    v_exp_f32 v61, v45
    v_exp_f32 v62, v46
    v_exp_f32 v63, v47
    v_exp_f32 v64, v48
    v_exp_f32 v65, v49
    v_exp_f32 v66, v50
    v_exp_f32 v67, v51
    v_exp_f32 v68, v52
    v_exp_f32 v69, v53
    v_exp_f32 v70, v54
    v_exp_f32 v71, v55
    s_nop 0
    v_cvt_pk_bf16_f32 v104, v56, v57
    v_cvt_pk_bf16_f32 v105, v58, v59
    v_cvt_pk_bf16_f32 v106, v60, v61
    v_cvt_pk_bf16_f32 v107, v62, v63
    v_cvt_pk_bf16_f32 v108, v64, v65
    v_cvt_pk_bf16_f32 v109, v66, v67
    v_cvt_pk_bf16_f32 v110, v68, v69
    v_cvt_pk_bf16_f32 v111, v70, v71
    s_nop 1
    v_mfma_f32_32x32x16_bf16 v[72:87], a[8:11], v[104:107], v[72:87]
    v_mfma_f32_32x32x16_bf16 v[72:87], a[12:15], v[108:111], v[72:87]
    s_add_u32 s58, s58, 4096
    s_add_u32 s59, s59, 1
    s_cmp_lt_u32 s59, 64
    s_cbranch_scc1 L_slow2
    s_nop 15
    v_mov_b32 v40, v84
    v_mov_b32 v41, v84
    s_nop 1
    v_permlane32_swap_b32 v40, v41
    s_nop 1
    v_rcp_f32 v42, v41
    s_cmp_lg_u32 s29, 0
    s_cbranch_scc1 L_slow3

    v_mov_b32 v56, v72
    v_mov_b32 v57, v73
    v_mov_b32 v58, v74
    v_mov_b32 v59, v75
    v_mov_b32 v60, v76
    v_mov_b32 v61, v77
    v_mov_b32 v62, v78
    v_mov_b32 v63, v79
    s_branch L_store
L_slow3:
    v_mov_b32 v56, v80
    v_mov_b32 v57, v81
    v_mov_b32 v58, v82
    v_mov_b32 v59, v83
    v_mov_b32 v60, v84
    v_mov_b32 v61, v85
    v_mov_b32 v62, v86
    v_mov_b32 v63, v87
    s_branch L_store
L_end:
    s_endpgm
.section .rodata,"a"
.p2align 6
.amdhsa_kernel standalone__mha_block__prompt_kernel
  .amdhsa_next_free_vgpr 256
  .amdhsa_next_free_sgpr 72
  .amdhsa_accum_offset 128
  .amdhsa_group_segment_fixed_size 0
  .amdhsa_kernarg_size 48
  .amdhsa_user_sgpr_count 2
  .amdhsa_user_sgpr_kernarg_segment_ptr 1
  .amdhsa_system_sgpr_workgroup_id_x 1
.end_amdhsa_kernel
```
